```python
import torch

def _softmax(x, axis=-1):
    return torch.softmax(x, dim=axis)
def _gelu(x):
    return torch.nn.functional.gelu(x, approximate="tanh")
def _silu(x):
    return torch.nn.functional.silu(x)
def _sigmoid(x):
    return torch.sigmoid(x)
def _layernorm(x, axis=-1, eps=1e-5):
    m = x.mean(dim=axis, keepdim=True)
    v = x.var(dim=axis, keepdim=True, unbiased=False)
    return (x - m) / torch.sqrt(v + eps)
def _scatter_add(tgt, idx, src, axis=0):
    return tgt.clone().index_add_(axis, idx, src)
def _segment_sum(src, seg, n):
    out = torch.zeros((n,) + src.shape[1:], dtype=src.dtype)
    return out.index_add_(0, seg, src)
def _pad(x, pw):
    flat = tuple(v for pair in reversed(pw) for v in pair)
    return torch.nn.functional.pad(x, flat)

kernel_name = 'recurrent_scan__sliding_block_cached__geglu_ffn__decode'

def setup_inputs():

    _w = (lambda a: (lambda t: t.to(torch.bfloat16) if t.is_floating_point() else t)(torch.as_tensor(a)))
    def _A_setup():
        B, Sq, D = 2, 1, 576
        Hq, Hkv, Sk, Dh = 32, 16, 4096, 128
        assert Hq % Hkv == 0, (Hq, Hkv)
        return {
            "x": _w((lambda *s: torch.randn(*s, dtype=torch.bfloat16) * 0.05)(B, Sq, D)),
            "k_cache": _w((lambda *s: torch.randn(*s, dtype=torch.bfloat16) * 0.8)(B, Hkv, Sk, Dh)),
            "v_cache": _w((lambda *s: torch.randn(*s, dtype=torch.bfloat16) * 0.2)(B, Hkv, Sk, Dh)),
            "wq": _w((lambda *s: torch.randn(*s, dtype=torch.bfloat16) * 0.8)(D, Hq * Dh) * (D ** -0.5)),
            "wo": _w((lambda *s: torch.randn(*s, dtype=torch.bfloat16) * 0.2)(Hq * Dh, D) * ((Hq * Dh) ** -0.5)),
        }
    _A_in = _A_setup()

    def _B_setup():
        B, S, D, F = 2, 1, 576, 4608
        return {
            "x": _w((lambda *s: torch.randn(*s, dtype=torch.bfloat16) * 0.05)(B, S, D)),
            "w_gate": _w((lambda *s: torch.randn(*s, dtype=torch.bfloat16) * 0.1)(D, F)),
            "w_up": _w((lambda *s: torch.randn(*s, dtype=torch.bfloat16) * 0.1)(D, F)),
            "w_down": _w((lambda *s: torch.randn(*s, dtype=torch.bfloat16) * 0.1)(F, D)),
        }
    _B_in = _B_setup()

    return {
        "A_x": _A_in["x"],
        "A_k_cache": _A_in["k_cache"],
        "A_v_cache": _A_in["v_cache"],
        "A_wq": _A_in["wq"],
        "A_wo": _A_in["wo"],
        "B_x": _B_in["x"],
        "B_w_gate": _B_in["w_gate"],
        "B_w_up": _B_in["w_up"],
        "B_w_down": _B_in["w_down"],
    }

def reference(A_x, A_k_cache, A_v_cache, A_wq, A_wo, B_x, B_w_gate, B_w_up, B_w_down):
    def _A_ref(x, k_cache, v_cache, wq, wo):
        B, Sq, D = x.shape
        Hq, Dh = 32, 128
        Hkv, Sk = k_cache.shape[1], k_cache.shape[2]
        W = min(4096, max(256, Sk // 4))
        rep = Hq // Hkv
        q = (lambda x, *d: x.permute(*d))((x @ wq).reshape(B, Sq, Hq, Dh), 0, 2, 1, 3)
        k = (lambda x, n, axis: torch.repeat_interleave(x, n, dim=axis))(k_cache[:, :, Sk - W:, :], rep, axis=1)
        v = (lambda x, n, axis: torch.repeat_interleave(x, n, dim=axis))(v_cache[:, :, Sk - W:, :], rep, axis=1)
        scores = torch.einsum("bhqd,bhkd->bhqk", q, k) * (Dh ** -0.5)
        p = _softmax(scores, axis=-1)
        o = torch.einsum("bhqk,bhkd->bhqd", p, v)
        return (lambda x, *d: x.permute(*d))(o, 0, 2, 1, 3).reshape(B, Sq, Hq * Dh) @ wo

    def _B_ref(x, w_gate, w_up, w_down):
        return (_gelu(x @ w_gate) * (x @ w_up)) @ w_down

    x = A_x
    xn = _layernorm(x, axis=-1)
    s = _A_ref(xn, A_k_cache, A_v_cache, A_wq, A_wo)
    g = _silu(_B_ref(xn, B_w_gate, B_w_up, B_w_down))
    return x + s * g
```

```asm
; @launch grid=(256,1,1) block=(896,1,1) lds=86016
.amdgcn_target "amdgcn-amd-amdhsa--gfx950"
.text
.globl recurrent_scan__sliding_block_cached__geglu_ffn__decode_kernel
.p2align 12
.p2align 8
.type recurrent_scan__sliding_block_cached__geglu_ffn__decode_kernel,@function
recurrent_scan__sliding_block_cached__geglu_ffn__decode_kernel:
    s_cmp_ge_u32 s2, 256
    s_cbranch_scc1 L_exit
    s_load_dwordx16 s[16:31], s[0:1], 0
    s_load_dwordx8 s[32:39], s[0:1], 64
    s_load_dwordx2 s[12:13], s[0:1], 88
    s_getpc_b64 s[40:41]
L_pc:
    v_lshlrev_b32 v9, 4, v0
    v_min_u32 v9, KERNEL_END-L_pc-4, v9
    global_load_dword v67, v9, s[40:41]
    v_lshrrev_b32 v2, 6, v0
    v_and_b32 v1, 63, v0
    v_readfirstlane_b32 s3, v2
    v_lshlrev_b32 v9, 3, v0
    v_mov_b32 v4, -2
    v_mov_b32 v5, -2
    ds_write_b64 v9, v[4:5]
    s_and_b32 s4, s2, 7
    s_lshr_b32 s6, s2, 4
    s_bfe_u32 s5, s2, 0x10003
    s_lshl_b32 s7, s4, 4
    s_add_u32 s7, s7, s6
    v_and_b32 v2, 15, v1
    v_lshrrev_b32 v3, 4, v1
    s_mov_b32 s50, 0xffffff00
    s_mov_b32 s11, 0x20000
    s_mov_b32 s14, 0x1000000
    s_mov_b32 s15, 0x20000
    s_sub_u32 s3, s3, 1
    s_cbranch_scc0 L_notM
    s_setprio 3
    v_lshrrev_b32 v11, 5, v1
    v_mul_u32_u24 v11, 1152, v11
    v_and_b32 v12, 31, v1
    v_mul_u32_u24 v12, 36, v12
    v_add_u32 v11, v11, v12
    s_cmp_eq_u32 s5, 0
    s_waitcnt lgkmcnt(0)
    s_cbranch_scc1 L_M_nox
    global_load_dwordx4 v[108:111], v11, s[16:17]
    global_load_dwordx4 v[112:115], v11, s[16:17] offset:16
    global_load_dword v116, v11, s[16:17] offset:32
L_M_nox:
    s_load_dword s52, s[38:39], 0
    s_barrier
    s_branch L_M2
L_notM:
    s_cmp_ge_u32 s3, 9
    s_cbranch_scc1 L_S
    s_cmp_eq_u32 s5, 1
    s_cbranch_scc1 L_X
    s_cmp_ge_u32 s3, 4
    s_cbranch_scc1 L_S
    s_bfe_u32 s40, s6, 0x10002
    s_lshl_b32 s40, s40, 4
    s_lshr_b32 s41, s7, 3
    s_add_u32 s40, s40, s41
    s_lshl_b32 s40, s40, 20
    s_and_b32 s41, s6, 3
    s_lshl_b32 s41, s41, 16
    s_add_u32 s40, s40, s41
    s_lshl_b32 s41, s3, 14
    s_add_u32 s40, s40, s41
    s_add_u32 s40, s40, 786432
    s_mov_b32 s42, s40
    s_add_u32 s41, s41, 20480
    s_mov_b32 m0, s41
    v_lshlrev_b32 v9, 8, v3
    v_add_u32 v16, 0, v3
    v_xor_b32 v16, v16, v2
    v_lshl_add_u32 v16, v16, 4, v9
    v_add_u32 v17, 4, v3
    v_xor_b32 v17, v17, v2
    v_lshl_add_u32 v17, v17, 4, v9
    v_add_u32 v18, 8, v3
    v_xor_b32 v18, v18, v2
    v_lshl_add_u32 v18, v18, 4, v9
    v_add_u32 v19, 12, v3
    v_xor_b32 v19, v19, v2
    v_lshl_add_u32 v19, v19, 4, v9
    s_mov_b32 s10, 33554432
    s_waitcnt lgkmcnt(0)
    s_mov_b32 s8, s18
    s_mov_b32 s9, s19
    buffer_load_dwordx4 v16, s[8:11], s40 offen offset:0 nt lds
    buffer_load_dwordx4 v17, s[8:11], s40 offen offset:1024 nt lds
    buffer_load_dwordx4 v18, s[8:11], s40 offen offset:2048 nt lds
    buffer_load_dwordx4 v19, s[8:11], s40 offen offset:3072 nt lds
    s_barrier
    s_branch L_L
L_X:
    s_and_b32 s40, s6, 3
    s_mul_i32 s40, s40, 144
    s_lshl_b32 s41, s3, 4
    s_add_u32 s47, s40, s41
    s_lshl_b32 s40, s47, 13
    s_and_b32 s41, s6, 12
    s_lshr_b32 s41, 0x1320, s41
    s_and_b32 s41, s41, 3
    s_lshl2_add_u32 s41, s4, s41
    s_lshl_b32 s41, s41, 8
    s_add_u32 s40, s40, s41
    v_lshlrev_b32 v11, 15, v3
    v_lshl_add_u32 v11, v2, 4, v11
    s_mov_b32 s10, 4718592
    s_movk_i32 s42, 0x2000
    s_waitcnt lgkmcnt(0)
    s_mov_b32 s8, s22
    s_mov_b32 s9, s23
    buffer_load_dwordx4 v[16:19], v11, s[8:11], s40 offen nt
    s_add_u32 s40, s40, s42
    buffer_load_dwordx4 v[20:23], v11, s[8:11], s40 offen nt
    s_add_u32 s40, s40, s42
    buffer_load_dwordx4 v[24:27], v11, s[8:11], s40 offen nt
    s_add_u32 s40, s40, s42
    buffer_load_dwordx4 v[28:31], v11, s[8:11], s40 offen nt
    s_barrier
    s_branch L_X2
L_S:
    s_cmp_eq_u32 s5, 0
    s_cbranch_scc1 L_S_bar
    v_lshlrev_b32 v9, 4, v0
    v_mov_b32 v4, 0
    v_mov_b32 v5, 0
    v_mov_b32 v6, 0
    v_mov_b32 v7, 0
    ds_write_b128 v9, v[4:7] offset:19456
    ds_write_b128 v9, v[4:7] offset:23552
    ds_write_b128 v9, v[4:7] offset:27648
    ds_write_b128 v9, v[4:7] offset:31744
    ds_write_b128 v9, v[4:7] offset:35840
L_S_bar:
    s_waitcnt lgkmcnt(0)
    s_barrier
    s_cmp_lt_u32 s3, 8
    s_cbranch_scc1 L_S2
    s_cmp_ge_u32 s3, 9
    s_cbranch_scc1 L_D
L_exit:
    s_endpgm
L_L:
    s_setprio 3
    v_lshlrev_b32 v20, 10, v3
    v_lshl_add_u32 v20, v2, 4, v20
    s_lshl_b32 s44, s3, 2
    s_add_u32 s44, s44, 5792
    v_and_b32 v9, 1, v1
    v_lshlrev_b32 v9, 4, v9
    v_mov_b32 v10, 0xffff
    v_lshlrev_b32 v10, v9, v10
    v_bfe_u32 v9, v1, 1, 2
    v_cmp_eq_u32 s[76:77], 0, v9
    v_cmp_eq_u32 s[78:79], 1, v9
    v_cmp_eq_u32 s[80:81], 2, v9
    v_cmp_eq_u32 s[82:83], 3, v9
    v_cndmask_b32 v4, 0, v10, s[76:77]
    v_cndmask_b32 v5, 0, v10, s[78:79]
    v_cndmask_b32 v6, 0, v10, s[80:81]
    v_cndmask_b32 v7, 0, v10, s[82:83]
    s_waitcnt vmcnt(3)
    s_add_u32 s41, s41, 4096
    s_mov_b32 m0, s41
    s_add_u32 s40, s40, 4096
    buffer_load_dwordx4 v16, s[8:11], s40 offen offset:0 nt lds
    buffer_load_dwordx4 v17, s[8:11], s40 offen offset:1024 nt lds
    s_waitcnt vmcnt(4)
    buffer_load_dwordx4 v18, s[8:11], s40 offen offset:2048 nt lds
    buffer_load_dwordx4 v19, s[8:11], s40 offen offset:3072 nt lds
    s_waitcnt vmcnt(5)
    s_add_u32 s41, s41, 4096
    s_mov_b32 m0, s41
    s_add_u32 s40, s40, 4096
    buffer_load_dwordx4 v16, s[8:11], s40 offen offset:0 nt lds
    buffer_load_dwordx4 v17, s[8:11], s40 offen offset:1024 nt lds
    s_waitcnt vmcnt(6)
    buffer_load_dwordx4 v18, s[8:11], s40 offen offset:2048 nt lds
    buffer_load_dwordx4 v19, s[8:11], s40 offen offset:3072 nt lds
    s_waitcnt vmcnt(7)
    s_add_u32 s41, s41, 4096
    s_mov_b32 m0, s41
    s_add_u32 s40, s40, 4096
    buffer_load_dwordx4 v16, s[8:11], s40 offen offset:0 nt lds
    s_waitcnt vmcnt(7)
    buffer_load_dwordx4 v17, s[8:11], s40 offen offset:1024 nt lds
    v_mov_b32 v9, 5788
    v_mov_b32 v10, 0
    s_mov_b64 exec, 1
    ds_write_b32 v9, v10
    s_mov_b64 exec, -1
    s_waitcnt vmcnt(7)
    buffer_load_dwordx4 v18, s[8:11], s40 offen offset:2048 nt lds
    s_waitcnt vmcnt(7)
    buffer_load_dwordx4 v19, s[8:11], s40 offen offset:3072 nt lds
    s_waitcnt vmcnt(7)
    s_mov_b32 s8, s20
    s_mov_b32 s9, s21
    buffer_load_dwordx4 v[64:67], v20, s[8:11], s42 offen offset:0 nt
    s_waitcnt vmcnt(7)
    buffer_load_dwordx4 v[68:71], v20, s[8:11], s42 offen offset:256 nt
    s_waitcnt vmcnt(7)
    buffer_load_dwordx4 v[72:75], v20, s[8:11], s42 offen offset:512 nt
    s_waitcnt vmcnt(7)
    buffer_load_dwordx4 v[76:79], v20, s[8:11], s42 offen offset:768 nt
    s_waitcnt vmcnt(7)
    s_add_u32 s42, s42, 4096
    buffer_load_dwordx4 v[80:83], v20, s[8:11], s42 offen offset:0 nt
    s_waitcnt vmcnt(7)
    buffer_load_dwordx4 v[84:87], v20, s[8:11], s42 offen offset:256 nt
    s_waitcnt vmcnt(7)
    buffer_load_dwordx4 v[88:91], v20, s[8:11], s42 offen offset:512 nt
    s_waitcnt vmcnt(7)
    buffer_load_dwordx4 v[92:95], v20, s[8:11], s42 offen offset:768 nt
    v_mov_b32 v9, s44
    v_mov_b32 v10, 0
    s_mov_b64 exec, 1
    ds_write_b32 v9, v10
    s_mov_b64 exec, -1
    s_waitcnt vmcnt(7)
    s_add_u32 s42, s42, 4096
    buffer_load_dwordx4 v[96:99], v20, s[8:11], s42 offen offset:0 nt
    s_waitcnt vmcnt(7)
    buffer_load_dwordx4 v[100:103], v20, s[8:11], s42 offen offset:256 nt
    s_waitcnt vmcnt(7)
    buffer_load_dwordx4 v[104:107], v20, s[8:11], s42 offen offset:512 nt
    s_waitcnt vmcnt(7)
    buffer_load_dwordx4 v[108:111], v20, s[8:11], s42 offen offset:768 nt
    s_waitcnt vmcnt(7)
    s_add_u32 s42, s42, 4096
    buffer_load_dwordx4 v[112:115], v20, s[8:11], s42 offen offset:0 nt
    v_mov_b32 v9, 5808
    v_mov_b32 v10, 1
    s_mov_b64 exec, 1
    ds_add_u32 v9, v10
    s_mov_b64 exec, -1
    s_waitcnt vmcnt(7)
    buffer_load_dwordx4 v[116:119], v20, s[8:11], s42 offen offset:256 nt
    s_waitcnt vmcnt(7)
    buffer_load_dwordx4 v[120:123], v20, s[8:11], s42 offen offset:512 nt
    s_waitcnt vmcnt(7)
    buffer_load_dwordx4 v[124:127], v20, s[8:11], s42 offen offset:768 nt
    v_mov_b32 v9, 5760
    s_mov_b32 s51, 1000000
L_spin_1:
    ds_read_b32 v8, v9
    s_waitcnt lgkmcnt(0)
    v_cmp_eq_u32 vcc, -2, v8
    s_cbranch_vccz L_spun_2
    s_sub_u32 s51, s51, 1
    s_cbranch_scc1 L_abort
    s_sleep 1
    s_branch L_spin_1
L_spun_2:
    v_bfe_u32 v11, v1, 3, 1
    v_lshlrev_b32 v11, 10, v11
    v_lshl_add_u32 v11, v3, 4, v11
    s_lshl_b32 s41, s3, 8
    v_add_u32 v11, s41, v11
    s_lshl_b32 s45, s7, 10
    s_add_u32 s45, s45, 372736
    s_add_u32 s46, s45, 499712
    s_mov_b32 s51, 1000000
L_spin_4:
    ds_read_b128 v[16:19], v11 offset:0
    ds_read_b128 v[20:23], v11 offset:64
    ds_read_b128 v[24:27], v11 offset:128
    ds_read_b128 v[28:31], v11 offset:192
    s_waitcnt lgkmcnt(0)
    v_max3_u32 v9, v16, v17, v18
    v_max3_u32 v9, v9, v19, v20
    v_max3_u32 v9, v9, v21, v22
    v_max3_u32 v9, v9, v23, v24
    v_max3_u32 v9, v9, v25, v26
    v_max3_u32 v9, v9, v27, v28
    v_max3_u32 v9, v9, v29, v30
    v_max_u32 v9, v9, v31
    v_cmp_eq_u32 vcc, -2, v9
    s_cbranch_vccz L_spun_5
    s_sub_u32 s51, s51, 1
    s_cbranch_scc1 L_abort
    s_sleep 1
    s_branch L_spin_4
L_spun_5:
    v_and_b32 v32, v16, v4
    v_and_b32 v33, v16, v5
    v_and_b32 v34, v16, v6
    v_and_b32 v35, v16, v7
    v_and_b32 v36, v17, v4
    v_and_b32 v37, v17, v5
    v_and_b32 v38, v17, v6
    v_and_b32 v39, v17, v7
    s_waitcnt vmcnt(15)
    v_mfma_f32_16x16x32_bf16 v[12:15], v[32:35], v[64:67], 0
    v_and_b32 v40, v18, v4
    v_and_b32 v41, v18, v5
    v_and_b32 v42, v18, v6
    v_and_b32 v43, v18, v7
    s_waitcnt vmcnt(14)
    v_mfma_f32_16x16x32_bf16 v[12:15], v[36:39], v[68:71], v[12:15]
    v_and_b32 v44, v19, v4
    v_and_b32 v45, v19, v5
    v_and_b32 v46, v19, v6
    v_and_b32 v47, v19, v7
    s_waitcnt vmcnt(13)
    v_mfma_f32_16x16x32_bf16 v[12:15], v[40:43], v[72:75], v[12:15]
    v_and_b32 v48, v20, v4
    v_and_b32 v49, v20, v5
    v_and_b32 v50, v20, v6
    v_and_b32 v51, v20, v7
    s_waitcnt vmcnt(12)
    v_mfma_f32_16x16x32_bf16 v[12:15], v[44:47], v[76:79], v[12:15]
    v_and_b32 v52, v21, v4
    v_and_b32 v53, v21, v5
    v_and_b32 v54, v21, v6
    v_and_b32 v55, v21, v7
    s_waitcnt vmcnt(11)
    v_mfma_f32_16x16x32_bf16 v[12:15], v[48:51], v[80:83], v[12:15]
    v_and_b32 v56, v22, v4
    v_and_b32 v57, v22, v5
    v_and_b32 v58, v22, v6
    v_and_b32 v59, v22, v7
    s_waitcnt vmcnt(10)
    v_mfma_f32_16x16x32_bf16 v[12:15], v[52:55], v[84:87], v[12:15]
    v_and_b32 v60, v23, v4
    v_and_b32 v61, v23, v5
    v_and_b32 v62, v23, v6
    v_and_b32 v63, v23, v7
    s_waitcnt vmcnt(9)
    v_mfma_f32_16x16x32_bf16 v[12:15], v[56:59], v[88:91], v[12:15]
    v_and_b32 v32, v24, v4
    v_and_b32 v33, v24, v5
    v_and_b32 v34, v24, v6
    v_and_b32 v35, v24, v7
    v_and_b32 v36, v25, v4
    v_and_b32 v37, v25, v5
    v_and_b32 v38, v25, v6
    v_and_b32 v39, v25, v7
    s_waitcnt vmcnt(8)
    v_mfma_f32_16x16x32_bf16 v[12:15], v[60:63], v[92:95], v[12:15]
    v_and_b32 v40, v26, v4
    v_and_b32 v41, v26, v5
    v_and_b32 v42, v26, v6
    v_and_b32 v43, v26, v7
    v_and_b32 v44, v27, v4
    v_and_b32 v45, v27, v5
    v_and_b32 v46, v27, v6
    v_and_b32 v47, v27, v7
    s_waitcnt vmcnt(7)
    v_mfma_f32_16x16x32_bf16 v[12:15], v[32:35], v[96:99], v[12:15]
    v_and_b32 v48, v28, v4
    v_and_b32 v49, v28, v5
    v_and_b32 v50, v28, v6
    v_and_b32 v51, v28, v7
    v_and_b32 v52, v29, v4
    v_and_b32 v53, v29, v5
    v_and_b32 v54, v29, v6
    v_and_b32 v55, v29, v7
    s_waitcnt vmcnt(6)
    v_mfma_f32_16x16x32_bf16 v[12:15], v[36:39], v[100:103], v[12:15]
    v_and_b32 v56, v30, v4
    v_and_b32 v57, v30, v5
    v_and_b32 v58, v30, v6
    v_and_b32 v59, v30, v7
    v_and_b32 v60, v31, v4
    v_and_b32 v61, v31, v5
    v_and_b32 v62, v31, v6
    v_and_b32 v63, v31, v7
    s_waitcnt vmcnt(5)
    v_mfma_f32_16x16x32_bf16 v[12:15], v[40:43], v[104:107], v[12:15]
    s_waitcnt vmcnt(4)
    v_mfma_f32_16x16x32_bf16 v[12:15], v[44:47], v[108:111], v[12:15]
    s_lshl_b32 s41, s3, 10
    v_lshlrev_b32 v17, 4, v1
    v_add_u32 v18, s41, v17
    v_and_b32 v19, 33, v1
    v_mul_u32_u24 v19, 0x110, v19
    v_and_b32 v19, 0x300, v19
    v_bfe_u32 v9, v1, 1, 4
    v_lshl_add_u32 v19, v9, 4, v19
    v_mov_b32 v9, 5768
    v_mov_b32 v10, 1
    s_waitcnt vmcnt(3)
    v_mfma_f32_16x16x32_bf16 v[12:15], v[48:51], v[112:115], v[12:15]
    s_waitcnt vmcnt(2)
    v_mfma_f32_16x16x32_bf16 v[12:15], v[52:55], v[116:119], v[12:15]
    s_waitcnt vmcnt(1)
    v_mfma_f32_16x16x32_bf16 v[12:15], v[56:59], v[120:123], v[12:15]
    s_waitcnt vmcnt(0)
    v_mfma_f32_16x16x32_bf16 v[12:15], v[60:63], v[124:127], v[12:15]
    s_nop 7
    ds_write_b128 v18, v[12:15] offset:8192
    s_mov_b64 exec, 1
    ds_add_rtn_u32 v11, v9, v10
    s_mov_b64 exec, -1
    ds_read_b128 v[32:35], v19 offset:8192
    ds_read_b128 v[36:39], v19 offset:9216
    ds_read_b128 v[40:43], v19 offset:10240
    ds_read_b128 v[44:47], v19 offset:11264
    s_waitcnt lgkmcnt(4)
    v_readfirstlane_b32 s84, v11
    s_nop 0
    s_cmp_eq_u32 s84, 1
    s_cbranch_scc0 L_wave_end
    s_waitcnt lgkmcnt(2)
    v_pk_add_f32 v[32:33], v[32:33], v[36:37]
    v_pk_add_f32 v[34:35], v[34:35], v[38:39]
    s_waitcnt lgkmcnt(0)
    v_pk_add_f32 v[40:41], v[40:41], v[44:45]
    v_pk_add_f32 v[42:43], v[42:43], v[46:47]
    v_pk_add_f32 v[32:33], v[32:33], v[40:41]
    v_pk_add_f32 v[34:35], v[34:35], v[42:43]
    v_and_or_b32 v32, v32, s50, v8
    v_and_or_b32 v33, v33, s50, v8
    v_and_or_b32 v34, v34, s50, v8
    v_and_or_b32 v35, v35, s50, v8
    buffer_store_dwordx4 v[32:35], v17, s[12:15], s46 offen
    v_mov_b32 v9, 5784
    v_mov_b32 v10, 0
    s_mov_b64 exec, 1
    ds_write_b32 v9, v10
    s_mov_b64 exec, -1
    s_setprio 0
    v_mov_b32 v9, 5828
    s_mov_b32 s51, 1000000
L_spin_7:
    ds_read_b32 v10, v9
    s_waitcnt lgkmcnt(0)
    v_cmp_eq_u32 vcc, -2, v10
    s_cbranch_vccz L_spun_8
    s_sub_u32 s51, s51, 1
    s_cbranch_scc1 L_abort
    s_sleep 4
    s_branch L_spin_7
L_spun_8:
    buffer_store_dwordx4 v[32:35], v17, s[12:15], s45 offen sc1
    s_endpgm
L_S2:
    s_sub_u32 s49, s3, 4
    s_lshl_b32 s41, s49, 14
    s_add_u32 s41, s41, 20480
    v_lshl_add_u32 v11, v2, 8, s41
    v_or_b32 v12, 0, v3
    v_xor_b32 v12, v12, v2
    v_lshl_add_u32 v12, v12, 4, v11
    v_or_b32 v13, 4, v3
    v_xor_b32 v13, v13, v2
    v_lshl_add_u32 v13, v13, 4, v11
    v_or_b32 v14, 8, v3
    v_xor_b32 v14, v14, v2
    v_lshl_add_u32 v14, v14, 4, v11
    v_or_b32 v15, 12, v3
    v_xor_b32 v15, v15, v2
    v_lshl_add_u32 v15, v15, 4, v11
    v_cmp_eq_u32 s[54:55], 1, v3
    v_cmp_eq_u32 s[56:57], 2, v3
    v_cmp_eq_u32 s[58:59], 3, v3
    s_lshl_b32 s53, s49, 2
    s_add_u32 s47, s53, 5792
    v_mov_b32 v4, s53
    v_mov_b32 v5, 0
    s_lshl_b32 s48, s49, 8
    v_lshl_add_u32 v6, v1, 2, s48
    v_mov_b32 v9, 5760
    s_mov_b32 s51, 1000000
L_spin_10:
    ds_read_b32 v8, v9
    s_waitcnt lgkmcnt(0)
    v_cmp_eq_u32 vcc, -2, v8
    s_cbranch_vccz L_spun_11
    s_sub_u32 s51, s51, 1
    s_cbranch_scc1 L_abort
    s_sleep 1
    s_branch L_spin_10
L_spun_11:
    v_mov_b32 v9, s47
    s_mov_b32 s51, 1000000
L_spin_13:
    ds_read_b32 v10, v9
    s_waitcnt lgkmcnt(0)
    v_cmp_eq_u32 vcc, -2, v10
    s_cbranch_vccz L_spun_14
    s_sub_u32 s51, s51, 1
    s_cbranch_scc1 L_abort
    s_sleep 2
    s_branch L_spin_13
L_spun_14:
    s_waitcnt vmcnt(0)
    ds_read_b128 v[64:67], v12 offset:0
    ds_read_b128 v[68:71], v13 offset:0
    ds_read_b128 v[72:75], v14 offset:0
    ds_read_b128 v[76:79], v15 offset:0
    ds_read_b128 v[80:83], v12 offset:4096
    ds_read_b128 v[84:87], v13 offset:4096
    ds_read_b128 v[88:91], v14 offset:4096
    ds_read_b128 v[92:95], v15 offset:4096
    ds_read_b128 v[96:99], v12 offset:8192
    ds_read_b128 v[100:103], v13 offset:8192
    ds_read_b128 v[104:107], v14 offset:8192
    ds_read_b128 v[108:111], v15 offset:8192
    ds_read_b128 v[112:115], v12 offset:12288
    ds_read_b128 v[116:119], v13 offset:12288
    ds_read_b128 v[120:123], v14 offset:12288
    ds_read_b128 v[124:127], v15 offset:12288
    v_and_b32 v11, 1, v1
    v_lshlrev_b32 v11, 8, v11
    v_lshl_add_u32 v11, v3, 4, v11
    v_mov_b32 v9, 5764
    s_mov_b32 s51, 1000000
L_spin_16:
    ds_read_b32 v10, v9
    s_waitcnt lgkmcnt(0)
    v_cmp_eq_u32 vcc, -2, v10
    s_cbranch_vccz L_spun_17
    s_sub_u32 s51, s51, 1
    s_cbranch_scc1 L_abort
    s_sleep 1
    s_branch L_spin_16
L_spun_17:
    ds_read_b128 v[16:19], v11 offset:7168
    ds_read_b128 v[20:23], v11 offset:7232
    ds_read_b128 v[24:27], v11 offset:7296
    ds_read_b128 v[28:31], v11 offset:7360
    s_waitcnt lgkmcnt(3)
    v_mfma_f32_16x16x32_bf16 v[32:35], v[16:19], v[64:67], 0
    v_mfma_f32_16x16x32_bf16 v[36:39], v[16:19], v[80:83], 0
    v_mfma_f32_16x16x32_bf16 v[40:43], v[16:19], v[96:99], 0
    v_mfma_f32_16x16x32_bf16 v[44:47], v[16:19], v[112:115], 0
    s_waitcnt lgkmcnt(2)
    v_mfma_f32_16x16x32_bf16 v[32:35], v[20:23], v[68:71], v[32:35]
    v_mfma_f32_16x16x32_bf16 v[36:39], v[20:23], v[84:87], v[36:39]
    v_mfma_f32_16x16x32_bf16 v[40:43], v[20:23], v[100:103], v[40:43]
    v_mfma_f32_16x16x32_bf16 v[44:47], v[20:23], v[116:119], v[44:47]
    s_waitcnt lgkmcnt(1)
    v_mfma_f32_16x16x32_bf16 v[32:35], v[24:27], v[72:75], v[32:35]
    v_mfma_f32_16x16x32_bf16 v[36:39], v[24:27], v[88:91], v[36:39]
    v_mfma_f32_16x16x32_bf16 v[40:43], v[24:27], v[104:107], v[40:43]
    v_mfma_f32_16x16x32_bf16 v[44:47], v[24:27], v[120:123], v[44:47]
    s_waitcnt lgkmcnt(0)
    v_mfma_f32_16x16x32_bf16 v[32:35], v[28:31], v[76:79], v[32:35]
    v_mfma_f32_16x16x32_bf16 v[36:39], v[28:31], v[92:95], v[36:39]
    v_mfma_f32_16x16x32_bf16 v[40:43], v[28:31], v[108:111], v[40:43]
    v_mfma_f32_16x16x32_bf16 v[44:47], v[28:31], v[124:127], v[44:47]
    s_mov_b32 s48, 1040356334
    s_nop 4
    v_cndmask_b32 v32, v32, v36, s[54:55]
    v_cndmask_b32 v33, v33, v37, s[54:55]
    v_cndmask_b32 v32, v32, v40, s[56:57]
    v_cndmask_b32 v33, v33, v41, s[56:57]
    v_cndmask_b32 v32, v32, v44, s[58:59]
    v_cndmask_b32 v33, v33, v45, s[58:59]
    v_mul_f32 v32, s48, v32
    v_mul_f32 v33, s48, v33
    v_mov_b32 v34, v32
    v_mov_b32 v35, v33
    s_nop 0
    v_max_f32_dpp v34, v34, v34 quad_perm:[1,0,3,2] row_mask:0xf bank_mask:0xf
    v_max_f32_dpp v35, v35, v35 quad_perm:[1,0,3,2] row_mask:0xf bank_mask:0xf
    s_nop 0
    v_max_f32_dpp v34, v34, v34 quad_perm:[2,3,0,1] row_mask:0xf bank_mask:0xf
    v_max_f32_dpp v35, v35, v35 quad_perm:[2,3,0,1] row_mask:0xf bank_mask:0xf
    s_nop 0
    v_max_f32_dpp v34, v34, v34 row_half_mirror row_mask:0xf bank_mask:0xf
    v_max_f32_dpp v35, v35, v35 row_half_mirror row_mask:0xf bank_mask:0xf
    s_nop 0
    v_max_f32_dpp v34, v34, v34 row_mirror row_mask:0xf bank_mask:0xf
    v_max_f32_dpp v35, v35, v35 row_mirror row_mask:0xf bank_mask:0xf
    s_nop 0
    v_max_f32_dpp v34, v34, v34 row_bcast:15 row_mask:0xa bank_mask:0xf
    v_max_f32_dpp v35, v35, v35 row_bcast:15 row_mask:0xa bank_mask:0xf
    s_nop 0
    v_max_f32_dpp v34, v34, v34 row_bcast:31 row_mask:0xc bank_mask:0xf
    v_max_f32_dpp v35, v35, v35 row_bcast:31 row_mask:0xc bank_mask:0xf
    s_mov_b32 exec_lo, 0
    s_mov_b32 exec_hi, 0x80000000
    ds_write_b32 v4, v34 offset:5632
    ds_write_b32 v4, v35 offset:5648
    s_mov_b64 exec, -1
    s_mov_b32 s51, 1000000
L_spin_19:
    ds_read_b128 v[36:39], v5 offset:5632
    ds_read_b128 v[40:43], v5 offset:5648
    s_waitcnt lgkmcnt(0)
    v_max3_u32 v9, v36, v37, v38
    v_max3_u32 v9, v9, v39, v40
    v_max3_u32 v9, v9, v41, v42
    v_max_u32 v9, v9, v43
    v_cmp_eq_u32 vcc, -2, v9
    s_cbranch_vccz L_spun_20
    s_sub_u32 s51, s51, 1
    s_cbranch_scc1 L_abort
    s_branch L_spin_19
L_spun_20:
    v_max3_f32 v36, v36, v37, v38
    v_max3_f32 v40, v40, v41, v42
    v_max_f32 v36, v36, v39
    v_max_f32 v40, v40, v43
    v_sub_f32 v32, v32, v36
    v_sub_f32 v33, v33, v40
    v_exp_f32 v32, v32
    v_exp_f32 v33, v33
    v_cvt_pk_bf16_f32 v32, v32, v32
    v_cvt_pk_bf16_f32 v33, v33, v33
    ds_write_b32 v6, v32 offset:0
    ds_write_b32 v6, v33 offset:1024
    v_and_b32 v34, 0xffff0000, v32
    v_and_b32 v35, 0xffff0000, v33
    s_nop 0
    v_add_f32_dpp v34, v34, v34 quad_perm:[1,0,3,2] row_mask:0xf bank_mask:0xf
    v_add_f32_dpp v35, v35, v35 quad_perm:[1,0,3,2] row_mask:0xf bank_mask:0xf
    s_nop 0
    v_add_f32_dpp v34, v34, v34 quad_perm:[2,3,0,1] row_mask:0xf bank_mask:0xf
    v_add_f32_dpp v35, v35, v35 quad_perm:[2,3,0,1] row_mask:0xf bank_mask:0xf
    s_nop 0
    v_add_f32_dpp v34, v34, v34 row_half_mirror row_mask:0xf bank_mask:0xf
    v_add_f32_dpp v35, v35, v35 row_half_mirror row_mask:0xf bank_mask:0xf
    s_nop 0
    v_add_f32_dpp v34, v34, v34 row_mirror row_mask:0xf bank_mask:0xf
    v_add_f32_dpp v35, v35, v35 row_mirror row_mask:0xf bank_mask:0xf
    s_nop 0
    v_add_f32_dpp v34, v34, v34 row_bcast:15 row_mask:0xa bank_mask:0xf
    v_add_f32_dpp v35, v35, v35 row_bcast:15 row_mask:0xa bank_mask:0xf
    s_nop 0
    v_add_f32_dpp v34, v34, v34 row_bcast:31 row_mask:0xc bank_mask:0xf
    v_add_f32_dpp v35, v35, v35 row_bcast:31 row_mask:0xc bank_mask:0xf
    v_mov_b32 v9, 5772
    v_mov_b32 v10, 1
    v_lshrrev_b32 v5, 5, v1
    v_lshlrev_b32 v5, 4, v5
    s_mov_b32 exec_lo, 0
    s_mov_b32 exec_hi, 0x80000000
    ds_write_b32 v4, v34 offset:5664
    ds_write_b32 v4, v35 offset:5680
    s_mov_b64 exec, 1
    ds_add_rtn_u32 v11, v9, v10
    s_mov_b64 exec, -1
    ds_read_b128 v[44:47], v5 offset:5664
    s_waitcnt lgkmcnt(1)
    v_readfirstlane_b32 s84, v11
    s_nop 0
    s_cmp_eq_u32 s84, 1
    s_cbranch_scc0 L_wave_end
    v_cmp_lt_u32 vcc, 31, v1
    v_lshlrev_b32 v5, 2, v5
    v_lshl_add_u32 v5, v2, 4, v5
    v_cndmask_b32 v36, v36, v40, vcc
    s_lshl_b32 s45, s7, 7
    s_add_u32 s45, s45, 135168
    s_add_u32 s46, s45, 499712
    s_waitcnt lgkmcnt(0)
    v_add_f32 v44, v44, v45
    v_add_f32 v46, v46, v47
    v_add_f32 v44, v44, v46
    v_and_or_b32 v28, v36, s50, v8
    v_lshl_or_b32 v29, v36, 8, v8
    v_and_or_b32 v30, v44, s50, v8
    v_mov_b32 v31, v8
    s_mov_b32 exec_lo, 15
    s_mov_b32 exec_hi, 15
    buffer_store_dwordx4 v[28:31], v5, s[12:15], s46 offen
    s_setprio 0
    v_mov_b32 v9, 5828
    s_mov_b32 s51, 1000000
L_spin_22:
    ds_read_b32 v10, v9
    s_waitcnt lgkmcnt(0)
    v_cmp_eq_u32 vcc, -2, v10
    s_cbranch_vccz L_spun_23
    s_sub_u32 s51, s51, 1
    s_cbranch_scc1 L_abort
    s_sleep 4
    s_branch L_spin_22
L_spun_23:
    buffer_store_dwordx4 v[28:31], v5, s[12:15], s45 offen sc1
    s_endpgm
L_X2:
    s_setprio 3
    s_mul_i32 s57, s6, 9
    s_add_u32 s46, s57, s3
    s_lshr_b32 s52, s46, 4
    s_and_b32 s48, s46, 15
    s_mul_i32 s48, s48, 36
    s_and_b32 s43, s4, 1
    s_mul_i32 s41, s43, 5
    s_lshr_b32 s44, s52, 1
    s_add_u32 s41, s41, s44
    s_and_b32 s44, s52, 1
    s_cmp_eq_u32 s52, 8
    s_cselect_b32 s41, 4, s41
    s_cselect_b32 s43, s43, s44
    s_lshr_b32 s44, s4, 1
    s_mul_i32 s44, s44, 9
    s_add_u32 s41, s41, s44
    s_mul_i32 s44, s43, 36
    s_add_u32 s44, s44, s41
    s_cmp_eq_u32 s43, 1
    s_cselect_b32 s8, s30, s28
    s_cselect_b32 s9, s31, s29
    s_lshl_b32 s41, s41, 8
    s_mul_i32 s40, s48, 9216
    s_add_u32 s40, s40, s41
    s_mov_b32 s10, 5308416
    s_movk_i32 s42, 9216
    v_mul_u32_u24 v126, 9216, v3
    v_lshlrev_b32 v125, 2, v126
    v_lshl_add_u32 v125, v2, 4, v125
    v_lshl_add_u32 v126, v2, 4, v126
    v_and_b32 v9, 1, v1
    v_lshlrev_b32 v9, 4, v9
    v_mov_b32 v10, 0xffff
    v_lshlrev_b32 v10, v9, v10
    v_bfe_u32 v9, v1, 1, 2
    v_cmp_eq_u32 s[76:77], 0, v9
    v_cmp_eq_u32 s[78:79], 1, v9
    v_cmp_eq_u32 s[80:81], 2, v9
    v_cmp_eq_u32 s[82:83], 3, v9
    v_cndmask_b32 v4, 0, v10, s[76:77]
    v_cndmask_b32 v5, 0, v10, s[78:79]
    v_cndmask_b32 v6, 0, v10, s[80:81]
    v_cndmask_b32 v7, 0, v10, s[82:83]
    v_bfe_u32 v112, v1, 3, 1
    v_mul_u32_u24 v112, 2304, v112
    s_lshl_b32 s41, s48, 2
    v_add_u32 v113, s41, v112
    v_lshl_add_u32 v114, v3, 2, v113
    v_add_u32 v114, 128, v114
    v_lshl_add_u32 v113, v3, 4, v113
    s_lshl_b32 s41, s47, 2
    v_add_u32 v112, s41, v112
    v_lshl_add_u32 v112, v3, 4, v112
    v_lshlrev_b32 v115, 4, v1
    s_lshl_b32 s53, s52, 4
    s_sub_i32 s54, s53, s57
    s_add_i32 s55, s54, 16
    s_max_i32 s54, s54, 0
    s_min_i32 s55, s55, 9
    s_sub_u32 s90, s3, s54
    s_lshl_b32 s90, s90, 10
    s_sub_i32 s54, s55, s54
    s_sub_i32 s54, s54, 3
    s_mul_i32 s59, s53, 7282
    s_lshr_b32 s59, s59, 16
    s_sub_u32 s59, s6, s59
    s_mul_i32 s56, s44, 3
    s_add_u32 s56, s56, s59
    s_lshl_b32 s56, s56, 10
    s_add_u32 s56, s56, 151552
    s_add_u32 s59, s56, 499712
    s_lshr_b32 s57, s57, 4
    s_sub_u32 s55, s52, s57
    s_mul_i32 s53, s55, 9216
    s_add_u32 s90, s90, s53
    s_lshl_b32 s55, s55, 2
    s_add_u32 s55, s55, 5768
    s_lshl_b32 s58, s3, 10
    s_waitcnt vmcnt(1)
    buffer_load_dwordx4 v[32:35], v125, s[8:11], s40 offen nt
    s_waitcnt vmcnt(1)
    s_add_u32 s40, s40, s42
    buffer_load_dwordx4 v[36:39], v125, s[8:11], s40 offen nt
    s_mov_b32 s51, 1000000
L_spin_25:
    ds_read_b128 v[116:119], v112
    s_waitcnt lgkmcnt(0)
    v_max3_u32 v9, v116, v117, v118
    v_max_u32 v9, v9, v119
    v_cmp_eq_u32 vcc, -2, v9
    s_cbranch_vccz L_spun_26
    s_sub_u32 s51, s51, 1
    s_cbranch_scc1 L_abort
    s_sleep 1
    s_branch L_spin_25
L_spun_26:
    v_mov_b32 v10, 5760
    ds_read_b32 v8, v10
    v_and_b32 v104, v116, v4
    v_and_b32 v105, v116, v5
    v_and_b32 v106, v116, v6
    v_and_b32 v107, v116, v7
    v_and_b32 v108, v117, v4
    v_and_b32 v109, v117, v5
    v_and_b32 v110, v117, v6
    v_and_b32 v111, v117, v7
    v_mfma_f32_16x16x32_bf16 v[12:15], v[104:107], v[16:19], 0
    v_and_b32 v104, v118, v4
    v_and_b32 v105, v118, v5
    v_and_b32 v106, v118, v6
    v_and_b32 v107, v118, v7
    v_mfma_f32_16x16x32_bf16 v[12:15], v[108:111], v[20:23], v[12:15]
    v_and_b32 v108, v119, v4
    v_and_b32 v109, v119, v5
    v_and_b32 v110, v119, v6
    v_and_b32 v111, v119, v7
    v_mfma_f32_16x16x32_bf16 v[12:15], v[104:107], v[24:27], v[12:15]
    s_nop 0
    v_mfma_f32_16x16x32_bf16 v[12:15], v[108:111], v[28:31], v[12:15]
    ds_read_b128 v[116:119], v113
    ds_read_b128 v[120:123], v113 offset:64
    ds_read_b32 v124, v114
    v_add_u32 v11, s58, v115
    s_nop 3
    ds_write_b128 v11, v[12:15] offset:20480
    v_mov_b32 v9, 5776
    v_mov_b32 v10, 1
    s_mov_b64 exec, 1
    ds_add_u32 v9, v10
    s_mov_b64 exec, -1
    s_mov_b32 s51, 1000000
    s_branch L_chk_30
L_spin_28:
    ds_read_b128 v[116:119], v113
    ds_read_b128 v[120:123], v113 offset:64
    ds_read_b32 v124, v114
L_chk_30:
    s_waitcnt lgkmcnt(0)
    v_max3_u32 v9, v116, v117, v118
    v_max3_u32 v9, v9, v119, v120
    v_max3_u32 v9, v9, v121, v122
    v_max3_u32 v9, v9, v123, v124
    v_cmp_eq_u32 vcc, -2, v9
    s_cbranch_vccz L_spun_29
    s_sub_u32 s51, s51, 1
    s_cbranch_scc1 L_abort
    s_sleep 1
    s_branch L_spin_28
L_spun_29:
    s_cmp_ge_u32 s6, 12
    s_cbranch_scc1 L_f4_31
    s_waitcnt vmcnt(1)
L_f4_31:
    s_add_u32 s40, s40, s42
    buffer_load_dwordx4 v[40:43], v125, s[8:11], s40 offen nt
    s_cmp_ge_u32 s6, 12
    s_cbranch_scc1 L_f4_32
    s_waitcnt vmcnt(1)
L_f4_32:
    s_waitcnt vmcnt(2)
    s_add_u32 s40, s40, s42
    buffer_load_dwordx4 v[44:47], v125, s[8:11], s40 offen nt
    v_and_b32 v104, v116, v4
    v_and_b32 v105, v116, v5
    v_and_b32 v106, v116, v6
    v_and_b32 v107, v116, v7
    s_nop 1
    v_mfma_f32_16x16x32_bf16 v[12:15], v[104:107], v[32:35], 0
    s_cmp_ge_u32 s6, 12
    s_cbranch_scc1 L_f4_33
    s_waitcnt vmcnt(1)
L_f4_33:
    s_waitcnt vmcnt(2)
    s_add_u32 s40, s40, 119808
    buffer_load_dwordx4 v[48:51], v125, s[8:11], s40 offen nt
    v_and_b32 v108, v117, v4
    v_and_b32 v109, v117, v5
    v_and_b32 v110, v117, v6
    v_and_b32 v111, v117, v7
    s_nop 1
    v_mfma_f32_16x16x32_bf16 v[12:15], v[108:111], v[36:39], v[12:15]
    s_cmp_ge_u32 s6, 12
    s_cbranch_scc1 L_f4_34
    s_waitcnt vmcnt(1)
L_f4_34:
    s_waitcnt vmcnt(2)
    s_add_u32 s40, s40, s42
    buffer_load_dwordx4 v[52:55], v125, s[8:11], s40 offen nt
    v_and_b32 v104, v118, v4
    v_and_b32 v105, v118, v5
    v_and_b32 v106, v118, v6
    v_and_b32 v107, v118, v7
    s_nop 1
    v_mfma_f32_16x16x32_bf16 v[12:15], v[104:107], v[40:43], v[12:15]
    s_cmp_ge_u32 s6, 12
    s_cbranch_scc1 L_f4_35
    s_waitcnt vmcnt(1)
L_f4_35:
    s_waitcnt vmcnt(2)
    s_add_u32 s40, s40, s42
    buffer_load_dwordx4 v[56:59], v125, s[8:11], s40 offen nt
    v_and_b32 v108, v119, v4
    v_and_b32 v109, v119, v5
    v_and_b32 v110, v119, v6
    v_and_b32 v111, v119, v7
    s_nop 1
    v_mfma_f32_16x16x32_bf16 v[12:15], v[108:111], v[44:47], v[12:15]
    s_cmp_ge_u32 s6, 12
    s_cbranch_scc1 L_f4_36
    s_waitcnt vmcnt(1)
L_f4_36:
    s_waitcnt vmcnt(2)
    s_add_u32 s40, s40, s42
    buffer_load_dwordx4 v[60:63], v125, s[8:11], s40 offen nt
    v_and_b32 v104, v120, v4
    v_and_b32 v105, v120, v5
    v_and_b32 v106, v120, v6
    v_and_b32 v107, v120, v7
    s_nop 1
    v_mfma_f32_16x16x32_bf16 v[12:15], v[104:107], v[48:51], v[12:15]
    s_cmp_ge_u32 s6, 12
    s_cbranch_scc1 L_f4_37
    s_waitcnt vmcnt(1)
L_f4_37:
    s_waitcnt vmcnt(2)
    s_add_u32 s40, s40, 119808
    buffer_load_dwordx4 v[64:67], v126, s[8:11], s40 offen nt
    v_mov_b32 v9, 5808
    v_mov_b32 v10, 1
    s_mov_b64 exec, 1
    ds_add_u32 v9, v10
    s_mov_b64 exec, -1
    v_and_b32 v108, v121, v4
    v_and_b32 v109, v121, v5
    v_and_b32 v110, v121, v6
    v_and_b32 v111, v121, v7
    s_nop 1
    v_mfma_f32_16x16x32_bf16 v[12:15], v[108:111], v[52:55], v[12:15]
    v_add_u32 v112, s90, v115
    v_and_b32 v113, 33, v1
    v_mul_u32_u24 v113, 0x110, v113
    v_and_b32 v113, 0x300, v113
    v_bfe_u32 v9, v1, 1, 4
    v_lshl_add_u32 v113, v9, 4, v113
    v_add_u32 v113, s53, v113
    v_mov_b32 v9, s55
    v_mov_b32 v10, 1
    v_mov_b32 v114, 5808
    v_and_b32 v104, v122, v4
    v_and_b32 v105, v122, v5
    v_and_b32 v106, v122, v6
    v_and_b32 v107, v122, v7
    s_waitcnt vmcnt(2)
    s_nop 0
    v_mfma_f32_16x16x32_bf16 v[12:15], v[104:107], v[56:59], v[12:15]
    v_and_b32 v108, v123, v4
    v_and_b32 v109, v123, v5
    v_and_b32 v110, v123, v6
    v_and_b32 v111, v123, v7
    s_waitcnt vmcnt(1)
    s_nop 0
    v_mfma_f32_16x16x32_bf16 v[12:15], v[108:111], v[60:63], v[12:15]
    v_and_b32 v104, v124, v4
    v_and_b32 v105, v124, v5
    v_and_b32 v106, v124, v6
    v_and_b32 v107, v124, v7
    s_waitcnt vmcnt(0)
    s_nop 0
    v_mfma_f32_16x16x32_bf16 v[12:15], v[104:107], v[64:67], v[12:15]
    s_nop 7
    ds_write_b128 v112, v[12:15] offset:29696
    s_mov_b64 exec, 1
    ds_add_rtn_u32 v11, v9, v10
    s_mov_b64 exec, -1
    ds_read_b128 v[68:71], v113 offset:29696
    ds_read_b128 v[72:75], v113 offset:30720
    ds_read_b128 v[76:79], v113 offset:31744
    ds_read_b128 v[80:83], v113 offset:32768
    ds_read_b128 v[84:87], v113 offset:33792
    ds_read_b128 v[88:91], v113 offset:34816
    ds_read_b128 v[92:95], v113 offset:35840
    ds_read_b128 v[96:99], v113 offset:36864
    ds_read_b128 v[100:103], v113 offset:37888
    s_waitcnt lgkmcnt(9)
    v_readfirstlane_b32 s84, v11
    s_nop 0
    s_cmp_eq_u32 s84, s54
    s_cbranch_scc0 L_wave_end
    s_waitcnt lgkmcnt(7)
    v_pk_add_f32 v[68:69], v[68:69], v[72:73]
    v_pk_add_f32 v[70:71], v[70:71], v[74:75]
    s_waitcnt lgkmcnt(5)
    v_pk_add_f32 v[76:77], v[76:77], v[80:81]
    v_pk_add_f32 v[78:79], v[78:79], v[82:83]
    v_pk_add_f32 v[68:69], v[68:69], v[76:77]
    v_pk_add_f32 v[70:71], v[70:71], v[78:79]
    s_waitcnt lgkmcnt(3)
    v_pk_add_f32 v[84:85], v[84:85], v[88:89]
    v_pk_add_f32 v[86:87], v[86:87], v[90:91]
    s_waitcnt lgkmcnt(1)
    v_pk_add_f32 v[92:93], v[92:93], v[96:97]
    v_pk_add_f32 v[94:95], v[94:95], v[98:99]
    v_pk_add_f32 v[84:85], v[84:85], v[92:93]
    v_pk_add_f32 v[86:87], v[86:87], v[94:95]
    s_waitcnt lgkmcnt(0)
    v_pk_add_f32 v[68:69], v[68:69], v[100:101]
    v_pk_add_f32 v[70:71], v[70:71], v[102:103]
    v_pk_add_f32 v[68:69], v[68:69], v[84:85]
    v_pk_add_f32 v[70:71], v[70:71], v[86:87]
    v_and_or_b32 v68, v68, s50, v8
    v_and_or_b32 v69, v69, s50, v8
    v_and_or_b32 v70, v70, s50, v8
    v_and_or_b32 v71, v71, s50, v8
    buffer_store_dwordx4 v[68:71], v115, s[12:15], s59 offen
    v_mov_b32 v9, 5784
    v_mov_b32 v10, 1
    s_mov_b64 exec, 1
    ds_add_u32 v9, v10
    s_mov_b64 exec, -1
    s_cmp_eq_u32 s52, 8
    s_cbranch_scc1 L_X_now
    s_setprio 0
    v_mov_b32 v9, 5828
    s_mov_b32 s51, 1000000
L_spin_38:
    ds_read_b32 v10, v9
    s_waitcnt lgkmcnt(0)
    v_cmp_eq_u32 vcc, -2, v10
    s_cbranch_vccz L_spun_39
    s_sub_u32 s51, s51, 1
    s_cbranch_scc1 L_abort
    s_sleep 4
    s_branch L_spin_38
L_spun_39:
L_X_now:
    buffer_store_dwordx4 v[68:71], v115, s[12:15], s56 offen sc1
    s_endpgm
L_D:
    s_sub_u32 s49, s3, 9
    v_lshlrev_b32 v57, 4, v1
    s_lshl_b32 s41, s49, 11
    v_add_u32 v58, s41, v57
    v_and_b32 v57, 33, v1
    v_mul_u32_u24 v57, 0x110, v57
    v_and_b32 v57, 0x300, v57
    v_bfe_u32 v9, v1, 1, 4
    v_lshl_add_u32 v57, v9, 4, v57
    s_lshl_b32 s41, s49, 10
    v_add_u32 v57, s41, v57
    v_and_b32 v9, 7, v1
    v_lshlrev_b32 v9, 4, v9
    s_movk_i32 s41, 9216
    v_lshrrev_b32 v59, 3, v1
    v_mad_u32_u24 v59, v59, s41, v9
    v_bfe_u32 v60, v1, 3, 1
    v_and_b32 v10, 2, v3
    v_add3_u32 v60, v60, v10, 8
    v_mad_u32_u24 v60, v60, s41, v9
    s_cmp_eq_u32 s49, 1
    s_cselect_b32 s54, 0xffff, -1
    s_mov_b32 s55, s54
    s_cselect_b64 vcc, -1, 0
    v_cndmask_b32 v59, v59, v60, vcc
    v_bfe_u32 v9, v1, 2, 1
    v_cmp_eq_u32 vcc, 0, v9
    v_mov_b32 v10, 0xffff
    s_nop 0
    v_cndmask_b32 v4, 0, v10, vcc
    v_xor_b32 v5, v4, v10
    v_lshlrev_b32 v6, 16, v4
    v_lshlrev_b32 v7, 16, v5
    v_mov_b32 v122, 5780
    v_mov_b32 v123, 1
    v_and_b32 v46, 3, v1
    v_mul_u32_u24 v46, 0x5555, v46
    v_mul_u32_u24 v44, 2560, v2
    s_lshl_b32 s41, s49, 7
    s_add_u32 s41, s41, 4608
    v_and_b32 v65, 1, v1
    v_lshlrev_b32 v65, 5, v65
    v_bfe_u32 v9, v1, 3, 1
    v_lshl_add_u32 v65, v9, 4, v65
    v_lshlrev_b32 v56, 6, v9
    v_bfe_u32 v9, v1, 4, 1
    v_lshl_add_u32 v65, v9, 3, v65
    v_bfe_u32 v9, v1, 1, 1
    v_lshl_add_u32 v65, v9, 2, v65
    v_bfe_u32 v9, v1, 2, 1
    v_lshl_add_u32 v65, v9, 1, v65
    v_lshrrev_b32 v120, 5, v1
    v_lshl_add_u32 v65, v120, 6, v65
    v_add_u32 v65, s41, v65
    v_lshl_add_u32 v56, v3, 4, v56
    v_add_u32 v56, s41, v56
    v_and_b32 v121, 31, v1
    v_mul_u32_u24 v125, 4608, v3
    v_lshrrev_b32 v9, 3, v2
    v_mul_u32_u24 v9, 18304, v9
    v_lshl_add_u32 v125, v2, 4, v125
    v_add_u32 v126, v9, v125
    v_mov_b32 v12, 0
    v_mov_b32 v13, 0
    v_mov_b32 v14, 0
    v_mov_b32 v15, 0
    v_mov_b32 v48, 0
    v_mov_b32 v49, 0
    v_mov_b32 v50, 0
    v_mov_b32 v51, 0
    v_mov_b32 v52, 0
    v_mov_b32 v53, 0
    v_mov_b32 v54, 0
    v_mov_b32 v55, 0
    v_mov_b32 v9, 5760
    s_mov_b32 s51, 1000000
L_spin_41:
    ds_read_b32 v8, v9
    s_waitcnt lgkmcnt(0)
    v_cmp_eq_u32 vcc, -2, v8
    s_cbranch_vccz L_spun_42
    s_sub_u32 s51, s51, 1
    s_cbranch_scc1 L_abort
    s_sleep 1
    s_branch L_spin_41
L_spun_42:
    v_mul_u32_u24 v45, 0x101, v8
    s_cmp_eq_u32 s5, 1
    s_cbranch_scc1 L_DG
    v_lshlrev_b32 v61, 12, v120
    v_lshl_add_u32 v61, v121, 2, v61
    v_and_b32 v10, 3, v1
    v_lshl_add_u32 v62, v120, 2, v10
    v_lshlrev_b32 v62, 7, v62
    s_mov_b32 s57, 0x07060501
    s_mov_b32 s58, 0
    s_mov_b32 s97, s6
    s_lshl2_add_u32 s89, s4, s97
    s_sub_u32 s89, s89, 12
    s_cmp_ge_u32 s97, 12
    s_cbranch_scc1 L_free
    s_mul_i32 s88, s97, 86
    s_lshr_b32 s88, s88, 8
    s_mul_i32 s87, s88, 3
    s_sub_u32 s87, s97, s87
    s_lshl2_add_u32 s86, s4, s88
    s_lshr_b32 s47, s86, 1
    s_lshl_b32 s48, s47, 10
    s_lshl_b32 s47, s47, 13
    s_and_b32 s41, s86, 1
    s_lshl_b32 s42, s41, 6
    s_add_u32 s48, s48, s42
    s_add_u32 s48, s48, 135168
    s_lshl_b32 s41, s41, 9
    s_add_u32 s47, s47, s41
    s_lshl_b32 s41, s49, 7
    s_add_u32 s47, s47, s41
    s_add_u32 s47, s47, 372736
    v_add_u32 v61, s47, v61
    v_add_u32 v62, s48, v62
    s_add_u32 s40, s86, 0
    s_lshl_b32 s43, s40, 7
    s_mul_i32 s41, s87, 110592
    s_add_u32 s43, s43, s41
    s_add_u32 s43, s43, 1003520
    s_lshr_b32 s41, s40, 2
    s_and_b32 s40, s40, 3
    s_mul_i32 s42, s87, 240
    s_add_u32 s41, s41, s42
    s_lshl_b32 s41, s41, 7
    s_lshl1_add_u32 s44, s40, s41
    s_add_u32 s44, s44, 1335296
    s_lshl2_add_u32 s45, s86, s49
    s_mul_i32 s45, s45, 36864
    s_mul_i32 s41, s87, 384
    s_add_u32 s45, s45, s41
    s_add_u32 s46, s45, 18432
    s_mov_b32 s8, s24
    s_mov_b32 s9, s25
    s_mov_b32 s10, 4718592
    s_mov_b32 s42, 499712
    buffer_load_dwordx4 v[24:27], v62, s[12:15], s42 offen sc1
    buffer_load_dword v20, v61, s[12:15], s42 offen offset:0 sc1
    buffer_load_dword v21, v61, s[12:15], s42 offen offset:1024 sc1
    buffer_load_dword v22, v61, s[12:15], s42 offen offset:2048 sc1
    buffer_load_dword v23, v61, s[12:15], s42 offen offset:3072 sc1
    v_mov_b32 v9, 5808
    s_mov_b32 s51, 1000000
L_spin_44:
    ds_read_b32 v10, v9
    s_waitcnt lgkmcnt(0)
    v_cmp_ne_u32 vcc, 2, v10
    s_cbranch_vccz L_spun_45
    s_sub_u32 s51, s51, 1
    s_cbranch_scc1 L_abort
    s_sleep 1
    s_branch L_spin_44
L_spun_45:
    buffer_load_dwordx4 v[68:71], v125, s[8:11], s45 offen offset:0 nt
    buffer_load_dwordx4 v[100:103], v126, s[8:11], s45 offen offset:256 nt
    buffer_load_dwordx4 v[84:87], v125, s[8:11], s46 offen offset:0 nt
    buffer_load_dwordx4 v[72:75], v125, s[8:11], s45 offen offset:1152 nt
    buffer_load_dwordx4 v[104:107], v126, s[8:11], s45 offen offset:1408 nt
    buffer_load_dwordx4 v[88:91], v125, s[8:11], s46 offen offset:1152 nt
    s_waitcnt vmcnt(5)
    buffer_load_dwordx4 v[76:79], v125, s[8:11], s45 offen offset:2304 nt
    s_waitcnt vmcnt(5)
    buffer_load_dwordx4 v[108:111], v126, s[8:11], s45 offen offset:2560 nt
    s_waitcnt vmcnt(5)
    buffer_load_dwordx4 v[92:95], v125, s[8:11], s46 offen offset:2304 nt
    s_waitcnt vmcnt(5)
    buffer_load_dwordx4 v[80:83], v125, s[8:11], s45 offen offset:3456 nt
    s_waitcnt vmcnt(5)
    buffer_load_dwordx4 v[112:115], v126, s[8:11], s45 offen offset:3712 nt
    s_waitcnt vmcnt(5)
    buffer_load_dwordx4 v[96:99], v125, s[8:11], s46 offen offset:3456 nt
    buffer_load_dwordx4 v[24:27], v62, s[12:15], s42 offen sc1
    v_mov_b32 v9, 5784
    s_mov_b32 s51, 1000000
L_spin_47:
    ds_read_b32 v10, v9
    s_waitcnt lgkmcnt(0)
    v_cmp_ne_u32 vcc, s58, v10
    s_cbranch_vccz L_spun_48
    s_sub_u32 s51, s51, 1
    s_cbranch_scc1 L_abort
    s_branch L_spin_47
L_spun_48:
    s_waitcnt vmcnt(0)
    buffer_load_dword v20, v61, s[12:15], s42 offen offset:0 sc1
    buffer_load_dword v21, v61, s[12:15], s42 offen offset:1024 sc1
    buffer_load_dword v22, v61, s[12:15], s42 offen offset:2048 sc1
    buffer_load_dword v23, v61, s[12:15], s42 offen offset:3072 sc1
    v_xor_b32 v24, v24, v8
    v_xor_b32 v25, v25, v8
    v_xor_b32 v26, v26, v8
    v_xor_b32 v27, v27, v8
    v_or3_b32 v9, v24, v25, v26
    v_or_b32 v9, v9, v27
    v_and_b32 v9, 0xff, v9
    v_cmp_ne_u32 vcc, 0, v9
    s_cbranch_vccz L_o_quick
    s_mov_b32 s51, 1
    s_branch L_first_51
L_hand_50:
    s_add_u32 s51, s51, 1
    s_cmp_gt_u32 s51, 1000000
    s_cbranch_scc1 L_abort
    s_cmp_lg_u32 s51, 7
    s_cbranch_scc1 L_keep_52
    s_mov_b64 exec, 1
    ds_write_b32 v122, v123 offset:48
    s_mov_b64 exec, -1
L_keep_52:
    s_and_b32 s41, s51, 7
    s_cselect_b32 s42, 499712, 0
L_first_51:
    s_waitcnt vmcnt(0)
    buffer_load_dwordx4 v[24:27], v62, s[12:15], s42 offen sc1
    buffer_load_dword v20, v61, s[12:15], s42 offen offset:0 sc1
    buffer_load_dword v21, v61, s[12:15], s42 offen offset:1024 sc1
    buffer_load_dword v22, v61, s[12:15], s42 offen offset:2048 sc1
    buffer_load_dword v23, v61, s[12:15], s42 offen offset:3072 sc1
    s_waitcnt vmcnt(0)
    v_xor_b32 v20, v20, v8
    v_xor_b32 v21, v21, v8
    v_xor_b32 v22, v22, v8
    v_xor_b32 v23, v23, v8
    v_xor_b32 v24, v24, v8
    v_xor_b32 v25, v25, v8
    v_xor_b32 v26, v26, v8
    v_xor_b32 v27, v27, v8
    v_or3_b32 v9, v20, v21, v22
    v_or3_b32 v9, v9, v23, v24
    v_or3_b32 v9, v9, v25, v26
    v_or_b32 v9, v9, v27
    v_and_b32 v9, 0xff, v9
    v_cmp_ne_u32 vcc, 0, v9
    s_cbranch_vccnz L_hand_50
    s_mov_b64 exec, 1
    ds_add_rtn_u32 v11, v122, v123
    s_mov_b64 exec, -1
    v_perm_b32 v28, v24, v25, s57
    v_mov_b32 v29, v28
    s_nop 1
    v_max_f32_dpp v29, v29, v29 quad_perm:[1,0,3,2] row_mask:0xf bank_mask:0xf
    s_nop 1
    v_max_f32_dpp v29, v29, v29 quad_perm:[2,3,0,1] row_mask:0xf bank_mask:0xf
    v_sub_f32 v28, v28, v29
    v_exp_f32 v28, v28
    s_nop 0
    v_mul_f32 v26, v26, v28
    v_mov_b32_dpp v40, v28 quad_perm:[0,0,0,0] row_mask:0xf bank_mask:0xf
    v_mov_b32_dpp v41, v28 quad_perm:[1,1,1,1] row_mask:0xf bank_mask:0xf
    v_add_f32_dpp v26, v26, v26 quad_perm:[1,0,3,2] row_mask:0xf bank_mask:0xf
    v_mov_b32_dpp v42, v28 quad_perm:[2,2,2,2] row_mask:0xf bank_mask:0xf
    v_mov_b32_dpp v43, v28 quad_perm:[3,3,3,3] row_mask:0xf bank_mask:0xf
    v_add_f32_dpp v26, v26, v26 quad_perm:[2,3,0,1] row_mask:0xf bank_mask:0xf
    v_rcp_f32 v26, v26
    s_branch L_o_sum
L_o_quick:
    v_perm_b32 v28, v24, v25, s57
    v_mov_b32 v29, v28
    s_nop 1
    v_max_f32_dpp v29, v29, v29 quad_perm:[1,0,3,2] row_mask:0xf bank_mask:0xf
    s_nop 1
    v_max_f32_dpp v29, v29, v29 quad_perm:[2,3,0,1] row_mask:0xf bank_mask:0xf
    v_sub_f32 v28, v28, v29
    v_exp_f32 v28, v28
    s_nop 0
    v_mul_f32 v26, v26, v28
    v_mov_b32_dpp v40, v28 quad_perm:[0,0,0,0] row_mask:0xf bank_mask:0xf
    v_mov_b32_dpp v41, v28 quad_perm:[1,1,1,1] row_mask:0xf bank_mask:0xf
    v_add_f32_dpp v26, v26, v26 quad_perm:[1,0,3,2] row_mask:0xf bank_mask:0xf
    v_mov_b32_dpp v42, v28 quad_perm:[2,2,2,2] row_mask:0xf bank_mask:0xf
    v_mov_b32_dpp v43, v28 quad_perm:[3,3,3,3] row_mask:0xf bank_mask:0xf
    v_add_f32_dpp v26, v26, v26 quad_perm:[2,3,0,1] row_mask:0xf bank_mask:0xf
    v_rcp_f32 v26, v26
    s_mov_b32 s51, 1
    s_branch L_o_wait
L_hand_53:
    s_add_u32 s51, s51, 1
    s_cmp_gt_u32 s51, 1000000
    s_cbranch_scc1 L_abort
    s_cmp_lg_u32 s51, 7
    s_cbranch_scc1 L_keep_55
    s_mov_b64 exec, 1
    ds_write_b32 v122, v123 offset:48
    s_mov_b64 exec, -1
L_keep_55:
    s_and_b32 s41, s51, 7
    s_cselect_b32 s42, 499712, 0
L_first_54:
    s_waitcnt vmcnt(0)
    buffer_load_dword v20, v61, s[12:15], s42 offen offset:0 sc1
    buffer_load_dword v21, v61, s[12:15], s42 offen offset:1024 sc1
    buffer_load_dword v22, v61, s[12:15], s42 offen offset:2048 sc1
    buffer_load_dword v23, v61, s[12:15], s42 offen offset:3072 sc1
L_o_wait:
    s_waitcnt vmcnt(0)
    v_xor_b32 v20, v20, v8
    v_xor_b32 v21, v21, v8
    v_xor_b32 v22, v22, v8
    v_xor_b32 v23, v23, v8
    v_or3_b32 v9, v20, v21, v22
    v_or_b32 v9, v9, v23
    v_and_b32 v9, 0xff, v9
    v_cmp_ne_u32 vcc, 0, v9
    s_cbranch_vccnz L_hand_53
    s_mov_b64 exec, 1
    ds_add_rtn_u32 v11, v122, v123
    s_mov_b64 exec, -1
L_o_sum:
    v_mul_f32 v16, v40, v20
    v_mul_f32 v18, v42, v22
    v_fmac_f32 v16, v41, v21
    v_fmac_f32 v18, v43, v23
    v_add_f32 v16, v16, v18
    v_mul_f32 v16, v16, v26
    v_cvt_pk_bf16_f32 v16, v16, v16
    ds_write_b16 v65, v16
    ds_read_b128 v[116:119], v56
    s_waitcnt lgkmcnt(2)
    v_readfirstlane_b32 s84, v11
    s_nop 0
    s_cmp_eq_u32 s84, 1
    s_cbranch_scc0 L_nohint_56
    s_mov_b64 exec, 0xfff
    buffer_store_short v45, v44, s[12:15], s44 offen sc1
    s_mov_b64 exec, -1
L_nohint_56:
    s_waitcnt lgkmcnt(0)
    v_and_b32 v24, v116, v4
    v_and_b32 v25, v116, v5
    v_and_b32 v26, v116, v6
    v_and_b32 v27, v116, v7
    v_and_b32 v32, v118, v4
    v_and_b32 v33, v118, v5
    v_and_b32 v34, v118, v6
    v_and_b32 v35, v118, v7
    v_smfmac_f32_16x16x64_bf16 v[48:51], v[24:27], v[100:107], v46
    v_and_b32 v28, v117, v4
    v_and_b32 v29, v117, v5
    v_and_b32 v30, v117, v6
    v_and_b32 v31, v117, v7
    v_smfmac_f32_16x16x64_bf16 v[52:55], v[32:35], v[100:107], v46
    v_and_b32 v36, v119, v4
    v_and_b32 v37, v119, v5
    v_and_b32 v38, v119, v6
    v_and_b32 v39, v119, v7
    v_smfmac_f32_16x16x64_bf16 v[48:51], v[28:31], v[108:115], v46
    s_nop 0
    v_smfmac_f32_16x16x64_bf16 v[52:55], v[36:39], v[108:115], v46
    v_smfmac_f32_16x16x64_bf16 v[12:15], v[24:27], v[68:75], v46
    v_smfmac_f32_16x16x64_bf16 v[12:15], v[28:31], v[76:83], v46
    v_smfmac_f32_16x16x64_bf16 v[12:15], v[32:35], v[84:91], v46
    v_smfmac_f32_16x16x64_bf16 v[12:15], v[36:39], v[92:99], v46
    s_nop 3
    v_add_f32_dpp v48, v52, v48 row_ror:8 row_mask:0xf bank_mask:0xf
    v_add_f32_dpp v49, v53, v49 row_ror:8 row_mask:0xf bank_mask:0xf
    v_add_f32_dpp v50, v54, v50 row_ror:8 row_mask:0xf bank_mask:0xf
    v_add_f32_dpp v51, v55, v51 row_ror:8 row_mask:0xf bank_mask:0xf
    ds_write_b128 v58, v[48:51] offset:13312
    ds_write_b128 v58, v[12:15] offset:12288
    s_mov_b64 exec, 1
    ds_add_u32 v122, v123 offset:44
    s_mov_b64 exec, s[54:55]
    s_cmp_ge_u32 s49, 2
    s_cbranch_scc1 L_wave_end
    s_mov_b32 s51, 1000000
L_sum_57:
    ds_read_b32 v10, v122 offset:44
    ds_read_b128 v[16:19], v57 offset:12288
    ds_read_b128 v[20:23], v57 offset:14336
    ds_read_b128 v[24:27], v57 offset:16384
    ds_read_b128 v[28:31], v57 offset:18432
    s_sub_u32 s51, s51, 1
    s_cbranch_scc1 L_abort
    s_waitcnt lgkmcnt(4)
    v_cmp_ne_u32 vcc, 2, v10
    s_cbranch_vccnz L_sum_57
    s_waitcnt lgkmcnt(2)
    v_pk_add_f32 v[16:17], v[16:17], v[20:21]
    v_pk_add_f32 v[18:19], v[18:19], v[22:23]
    s_waitcnt lgkmcnt(0)
    v_pk_add_f32 v[24:25], v[24:25], v[28:29]
    v_pk_add_f32 v[26:27], v[26:27], v[30:31]
    v_pk_add_f32 v[16:17], v[16:17], v[24:25]
    v_pk_add_f32 v[18:19], v[18:19], v[26:27]
    v_and_or_b32 v16, v16, s50, v8
    v_and_or_b32 v17, v17, s50, v8
    v_and_or_b32 v18, v18, s50, v8
    v_and_or_b32 v19, v19, s50, v8
    buffer_store_dwordx4 v[16:19], v59, s[12:15], s43 offen sc1
    s_mov_b64 exec, 1
    ds_write_b32 v122, v123 offset:48
    s_endpgm
L_DG:
    v_lshlrev_b32 v47, 9, v120
    v_lshl_add_u32 v47, v121, 2, v47
    s_mov_b32 s59, 3184710632
    v_mov_b32 v66, 0xc0135761
    s_mul_i32 s41, s6, 9
    s_add_u32 s42, s41, 8
    s_lshr_b32 s41, s41, 4
    s_lshr_b32 s42, s42, 4
    s_sub_u32 s58, s42, s41
    s_sub_u32 s58, s58, 1
    s_mov_b32 s97, s6
    s_lshr_b32 s89, s4, 1
    s_add_u32 s89, s89, 32
    s_and_b32 s85, s4, 1
    s_lshl4_add_u32 s41, s85, s97
    s_cmp_eq_u32 s41, 29
    s_cbranch_scc1 L_free
    s_mov_b32 s89, -1
    s_cmp_ge_u32 s97, 14
    s_cbranch_scc1 L_free
    s_mul_i32 s88, s97, 86
    s_lshr_b32 s88, s88, 8
    s_mul_i32 s87, s88, 3
    s_sub_u32 s87, s97, s87
    s_mul_i32 s86, s85, 5
    s_add_u32 s86, s86, s88
    s_lshl1_add_u32 s41, s85, s87
    s_cmp_lt_u32 s97, 12
    s_cselect_b32 s86, s86, 4
    s_cselect_b32 s87, s87, s41
    s_cselect_b32 s48, 7, 0
    s_lshr_b32 s41, s4, 1
    s_mul_i32 s41, s41, 9
    s_add_u32 s86, s86, s41
    s_lshl_b32 s56, s88, 1
    s_add_u32 s57, s56, 1
    s_min_u32 s57, s57, 8
    s_bitcmp1_b32 0xee, s56
    s_cselect_b64 s[90:91], -1, 0
    s_cselect_b32 s56, 2, 1
    s_lshl_b32 s56, s56, 10
    s_bitcmp1_b32 0xee, s57
    s_cselect_b64 s[92:93], -1, 0
    s_cselect_b32 s57, 2, 1
    s_lshl_b32 s57, s57, 10
    s_mul_i32 s47, s86, 3072
    s_lshl_b32 s41, s49, 7
    s_add_u32 s47, s47, s41
    s_add_u32 s47, s47, 151552
    v_add_u32 v61, s47, v47
    v_add_u32 v62, 110592, v61
    v_add_u32 v63, s56, v61
    v_add_u32 v64, s57, v62
    s_add_u32 s40, s86, 32
    s_lshl_b32 s43, s40, 7
    s_mul_i32 s41, s87, 110592
    s_add_u32 s43, s43, s41
    s_add_u32 s43, s43, 1003520
    s_lshr_b32 s41, s40, 2
    s_and_b32 s40, s40, 3
    s_mul_i32 s42, s87, 240
    s_add_u32 s41, s41, s42
    s_lshl_b32 s41, s41, 7
    s_lshl1_add_u32 s44, s40, s41
    s_add_u32 s44, s44, 1335296
    s_lshl2_add_u32 s45, s86, s49
    s_mul_i32 s45, s45, 36864
    s_mul_i32 s41, s87, 384
    s_add_u32 s45, s45, s41
    s_add_u32 s46, s45, 18432
    s_mov_b32 s8, s32
    s_mov_b32 s9, s33
    s_mov_b32 s10, 5308416
    s_cmp_eq_u32 s48, 0
    s_cselect_b32 s42, 0, 499712
    buffer_load_dword v16, v61, s[12:15], s42 offen sc1
    buffer_load_dword v17, v62, s[12:15], s42 offen sc1
    buffer_load_dword v18, v61, s[12:15], s42 offen offset:1024 sc1
    buffer_load_dword v19, v62, s[12:15], s42 offen offset:1024 sc1
    buffer_load_dword v20, v63, s[12:15], s42 offen sc1
    buffer_load_dword v21, v64, s[12:15], s42 offen sc1
    v_mov_b32 v9, 5808
    s_mov_b32 s51, 1000000
L_spin_59:
    ds_read_b32 v10, v9
    s_waitcnt lgkmcnt(0)
    v_cmp_ne_u32 vcc, 7, v10
    s_cbranch_vccz L_spun_60
    s_sub_u32 s51, s51, 1
    s_cbranch_scc1 L_abort
    s_sleep 1
    s_branch L_spin_59
L_spun_60:
    buffer_load_dwordx4 v[68:71], v125, s[8:11], s45 offen offset:0 nt
    buffer_load_dwordx4 v[100:103], v126, s[8:11], s45 offen offset:256 nt
    buffer_load_dwordx4 v[84:87], v125, s[8:11], s46 offen offset:0 nt
    buffer_load_dwordx4 v[72:75], v125, s[8:11], s45 offen offset:1152 nt
    buffer_load_dwordx4 v[104:107], v126, s[8:11], s45 offen offset:1408 nt
    buffer_load_dwordx4 v[88:91], v125, s[8:11], s46 offen offset:1152 nt
    s_waitcnt vmcnt(5)
    buffer_load_dwordx4 v[76:79], v125, s[8:11], s45 offen offset:2304 nt
    s_waitcnt vmcnt(5)
    buffer_load_dwordx4 v[108:111], v126, s[8:11], s45 offen offset:2560 nt
    s_waitcnt vmcnt(5)
    buffer_load_dwordx4 v[92:95], v125, s[8:11], s46 offen offset:2304 nt
    s_waitcnt vmcnt(5)
    buffer_load_dwordx4 v[80:83], v125, s[8:11], s45 offen offset:3456 nt
    s_waitcnt vmcnt(5)
    buffer_load_dwordx4 v[112:115], v126, s[8:11], s45 offen offset:3712 nt
    s_waitcnt vmcnt(5)
    buffer_load_dwordx4 v[96:99], v125, s[8:11], s46 offen offset:3456 nt
    v_mov_b32 v9, 5784
    s_mov_b32 s51, 1000000
L_spin_62:
    ds_read_b32 v10, v9
    s_waitcnt lgkmcnt(0)
    v_cmp_ne_u32 vcc, s58, v10
    s_cbranch_vccz L_spun_63
    s_sub_u32 s51, s51, 1
    s_cbranch_scc1 L_abort
    s_branch L_spin_62
L_spun_63:
    s_mov_b32 s51, 1
    s_branch L_first_66
L_hand_65:
    s_add_u32 s51, s51, 1
    s_cmp_gt_u32 s51, 1000000
    s_cbranch_scc1 L_abort
    s_cmp_lg_u32 s51, 7
    s_cbranch_scc1 L_keep_67
    s_mov_b64 exec, 1
    ds_write_b32 v122, v123 offset:48
    s_mov_b64 exec, -1
L_keep_67:
    s_and_b32 s41, s51, s48
    s_cselect_b32 s42, 499712, 0
L_first_66:
    s_waitcnt vmcnt(0)
    buffer_load_dword v16, v61, s[12:15], s42 offen sc1
    buffer_load_dword v17, v62, s[12:15], s42 offen sc1
    buffer_load_dword v18, v61, s[12:15], s42 offen offset:1024 sc1
    buffer_load_dword v19, v62, s[12:15], s42 offen offset:1024 sc1
    buffer_load_dword v20, v63, s[12:15], s42 offen sc1
    buffer_load_dword v21, v64, s[12:15], s42 offen sc1
    s_waitcnt vmcnt(0)
    v_xor_b32 v16, v16, v8
    v_xor_b32 v17, v17, v8
    v_xor_b32 v18, v18, v8
    v_xor_b32 v19, v19, v8
    v_xor_b32 v20, v20, v8
    v_xor_b32 v21, v21, v8
    v_or3_b32 v9, v16, v17, v18
    v_or3_b32 v9, v9, v19, v20
    v_or_b32 v9, v9, v21
    v_and_b32 v9, 0xff, v9
    v_cmp_ne_u32 vcc, 0, v9
    s_cbranch_vccnz L_hand_65
    s_mov_b64 exec, 1
    ds_add_rtn_u32 v11, v122, v123
    s_mov_b64 exec, -1
    v_cndmask_b32 v20, 0, v20, s[90:91]
    v_cndmask_b32 v21, 0, v21, s[92:93]
    v_pk_add_f32 v[16:17], v[16:17], v[18:19]
    v_pk_add_f32 v[16:17], v[16:17], v[20:21]
    v_cvt_pk_bf16_f32 v17, v16, v17
    v_lshlrev_b32 v16, 16, v17
    v_and_b32 v17, 0xffff0000, v17
    v_mul_f32 v18, v16, v16
    v_fma_f32 v18, v18, s59, v66
    v_mul_f32 v18, v18, v16
    v_exp_f32 v18, v18
    s_nop 0
    v_add_f32 v18, 1.0, v18
    v_rcp_f32 v18, v18
    s_nop 0
    v_mul_f32 v16, v16, v18
    v_cvt_pk_bf16_f32 v16, v16, v16
    v_and_b32 v16, 0xffff0000, v16
    v_mul_f32 v16, v16, v17
    v_cvt_pk_bf16_f32 v16, v16, v16
    ds_write_b16 v65, v16
    ds_read_b128 v[116:119], v56
    s_waitcnt lgkmcnt(2)
    v_readfirstlane_b32 s84, v11
    s_nop 0
    s_cmp_eq_u32 s84, 1
    s_cbranch_scc0 L_nohint_68
    s_mov_b64 exec, 0xfff
    buffer_store_short v45, v44, s[12:15], s44 offen sc1
    s_mov_b64 exec, -1
L_nohint_68:
    s_waitcnt lgkmcnt(0)
    v_and_b32 v24, v116, v4
    v_and_b32 v25, v116, v5
    v_and_b32 v26, v116, v6
    v_and_b32 v27, v116, v7
    v_and_b32 v32, v118, v4
    v_and_b32 v33, v118, v5
    v_and_b32 v34, v118, v6
    v_and_b32 v35, v118, v7
    v_smfmac_f32_16x16x64_bf16 v[48:51], v[24:27], v[100:107], v46
    v_and_b32 v28, v117, v4
    v_and_b32 v29, v117, v5
    v_and_b32 v30, v117, v6
    v_and_b32 v31, v117, v7
    v_smfmac_f32_16x16x64_bf16 v[52:55], v[32:35], v[100:107], v46
    v_and_b32 v36, v119, v4
    v_and_b32 v37, v119, v5
    v_and_b32 v38, v119, v6
    v_and_b32 v39, v119, v7
    v_smfmac_f32_16x16x64_bf16 v[48:51], v[28:31], v[108:115], v46
    s_nop 0
    v_smfmac_f32_16x16x64_bf16 v[52:55], v[36:39], v[108:115], v46
    v_smfmac_f32_16x16x64_bf16 v[12:15], v[24:27], v[68:75], v46
    v_smfmac_f32_16x16x64_bf16 v[12:15], v[28:31], v[76:83], v46
    v_smfmac_f32_16x16x64_bf16 v[12:15], v[32:35], v[84:91], v46
    v_smfmac_f32_16x16x64_bf16 v[12:15], v[36:39], v[92:99], v46
    s_nop 3
    v_add_f32_dpp v48, v52, v48 row_ror:8 row_mask:0xf bank_mask:0xf
    v_add_f32_dpp v49, v53, v49 row_ror:8 row_mask:0xf bank_mask:0xf
    v_add_f32_dpp v50, v54, v50 row_ror:8 row_mask:0xf bank_mask:0xf
    v_add_f32_dpp v51, v55, v51 row_ror:8 row_mask:0xf bank_mask:0xf
    ds_write_b128 v58, v[48:51] offset:13312
    ds_write_b128 v58, v[12:15] offset:12288
    s_mov_b64 exec, 1
    ds_add_u32 v122, v123 offset:44
    s_mov_b64 exec, s[54:55]
    s_cmp_ge_u32 s49, 2
    s_cbranch_scc1 L_wave_end
    s_mov_b32 s51, 1000000
L_sum_69:
    ds_read_b32 v10, v122 offset:44
    ds_read_b128 v[16:19], v57 offset:12288
    ds_read_b128 v[20:23], v57 offset:14336
    ds_read_b128 v[24:27], v57 offset:16384
    ds_read_b128 v[28:31], v57 offset:18432
    s_sub_u32 s51, s51, 1
    s_cbranch_scc1 L_abort
    s_waitcnt lgkmcnt(4)
    v_cmp_ne_u32 vcc, 2, v10
    s_cbranch_vccnz L_sum_69
    s_waitcnt lgkmcnt(2)
    v_pk_add_f32 v[16:17], v[16:17], v[20:21]
    v_pk_add_f32 v[18:19], v[18:19], v[22:23]
    s_waitcnt lgkmcnt(0)
    v_pk_add_f32 v[24:25], v[24:25], v[28:29]
    v_pk_add_f32 v[26:27], v[26:27], v[30:31]
    v_pk_add_f32 v[16:17], v[16:17], v[24:25]
    v_pk_add_f32 v[18:19], v[18:19], v[26:27]
    v_and_or_b32 v16, v16, s50, v8
    v_and_or_b32 v17, v17, s50, v8
    v_and_or_b32 v18, v18, s50, v8
    v_and_or_b32 v19, v19, s50, v8
    buffer_store_dwordx4 v[16:19], v59, s[12:15], s43 offen sc1
    s_mov_b64 exec, 1
    ds_write_b32 v122, v123 offset:48
    s_endpgm
L_free:
    v_mov_b32 v9, 5784
    s_mov_b32 s51, 1000000
L_spin_71:
    ds_read_b32 v10, v9
    s_waitcnt lgkmcnt(0)
    v_cmp_ne_u32 vcc, s58, v10
    s_cbranch_vccz L_spun_72
    s_sub_u32 s51, s51, 1
    s_cbranch_scc1 L_abort
    s_sleep 2
    s_branch L_spin_71
L_spun_72:
    v_mov_b32 v9, 5828
    v_mov_b32 v10, 0
    s_mov_b64 exec, 1
    ds_write_b32 v9, v10
    s_mov_b64 exec, -1
    s_cmp_lg_u32 s89, -1
    s_cbranch_scc1 L_R
L_wave_end:
    s_endpgm
L_M2:
    s_cmp_eq_u32 s5, 0
    s_cbranch_scc1 L_MA
    s_waitcnt vmcnt(0)
    v_lshlrev_b32 v16, 16, v108
    v_and_b32 v17, 0xffff0000, v108
    v_lshlrev_b32 v18, 16, v109
    v_and_b32 v19, 0xffff0000, v109
    v_lshlrev_b32 v20, 16, v110
    v_and_b32 v21, 0xffff0000, v110
    v_lshlrev_b32 v22, 16, v111
    v_and_b32 v23, 0xffff0000, v111
    v_lshlrev_b32 v24, 16, v112
    v_and_b32 v25, 0xffff0000, v112
    v_lshlrev_b32 v26, 16, v113
    v_and_b32 v27, 0xffff0000, v113
    v_lshlrev_b32 v28, 16, v114
    v_and_b32 v29, 0xffff0000, v114
    v_lshlrev_b32 v30, 16, v115
    v_and_b32 v31, 0xffff0000, v115
    v_lshlrev_b32 v32, 16, v116
    v_and_b32 v33, 0xffff0000, v116
    v_pk_add_f32 v[34:35], v[16:17], v[18:19]
    v_pk_add_f32 v[34:35], v[34:35], v[20:21]
    v_pk_add_f32 v[34:35], v[34:35], v[22:23]
    v_pk_add_f32 v[34:35], v[34:35], v[24:25]
    v_pk_add_f32 v[34:35], v[34:35], v[26:27]
    v_pk_add_f32 v[34:35], v[34:35], v[28:29]
    v_pk_add_f32 v[34:35], v[34:35], v[30:31]
    v_pk_add_f32 v[34:35], v[34:35], v[32:33]
    v_add_f32 v34, v34, v35
    s_nop 1
    v_add_f32_dpp v34, v34, v34 quad_perm:[1,0,3,2] row_mask:0xf bank_mask:0xf
    s_nop 1
    v_add_f32_dpp v34, v34, v34 quad_perm:[2,3,0,1] row_mask:0xf bank_mask:0xf
    s_nop 1
    v_add_f32_dpp v34, v34, v34 row_half_mirror row_mask:0xf bank_mask:0xf
    s_nop 1
    v_add_f32_dpp v34, v34, v34 row_mirror row_mask:0xf bank_mask:0xf
    v_mov_b32 v35, v34
    s_nop 1
    v_permlane16_swap_b32 v34, v35
    v_add_f32 v34, v34, v35
    v_mul_f32 v34, 0x3ae38e39, v34
    v_mov_b32 v35, v34
    v_pk_add_f32 v[36:37], v[16:17], v[34:35] neg_lo:[0,1] neg_hi:[0,1]
    v_pk_add_f32 v[38:39], v[18:19], v[34:35] neg_lo:[0,1] neg_hi:[0,1]
    v_pk_add_f32 v[40:41], v[20:21], v[34:35] neg_lo:[0,1] neg_hi:[0,1]
    v_pk_add_f32 v[42:43], v[22:23], v[34:35] neg_lo:[0,1] neg_hi:[0,1]
    v_pk_add_f32 v[44:45], v[24:25], v[34:35] neg_lo:[0,1] neg_hi:[0,1]
    v_pk_add_f32 v[46:47], v[26:27], v[34:35] neg_lo:[0,1] neg_hi:[0,1]
    v_pk_add_f32 v[48:49], v[28:29], v[34:35] neg_lo:[0,1] neg_hi:[0,1]
    v_pk_add_f32 v[50:51], v[30:31], v[34:35] neg_lo:[0,1] neg_hi:[0,1]
    v_pk_add_f32 v[52:53], v[32:33], v[34:35] neg_lo:[0,1] neg_hi:[0,1]
    v_pk_mul_f32 v[54:55], v[36:37], v[36:37]
    v_pk_fma_f32 v[54:55], v[38:39], v[38:39], v[54:55]
    v_pk_fma_f32 v[54:55], v[40:41], v[40:41], v[54:55]
    v_pk_fma_f32 v[54:55], v[42:43], v[42:43], v[54:55]
    v_pk_fma_f32 v[54:55], v[44:45], v[44:45], v[54:55]
    v_pk_fma_f32 v[54:55], v[46:47], v[46:47], v[54:55]
    v_pk_fma_f32 v[54:55], v[48:49], v[48:49], v[54:55]
    v_pk_fma_f32 v[54:55], v[50:51], v[50:51], v[54:55]
    v_pk_fma_f32 v[54:55], v[52:53], v[52:53], v[54:55]
    v_add_f32 v54, v54, v55
    s_nop 1
    v_add_f32_dpp v54, v54, v54 quad_perm:[1,0,3,2] row_mask:0xf bank_mask:0xf
    s_nop 1
    v_add_f32_dpp v54, v54, v54 quad_perm:[2,3,0,1] row_mask:0xf bank_mask:0xf
    s_nop 1
    v_add_f32_dpp v54, v54, v54 row_half_mirror row_mask:0xf bank_mask:0xf
    s_nop 1
    v_add_f32_dpp v54, v54, v54 row_mirror row_mask:0xf bank_mask:0xf
    v_mov_b32 v55, v54
    s_nop 1
    v_permlane16_swap_b32 v54, v55
    v_add_f32 v54, v54, v55
    v_mul_f32 v54, 0x3ae38e39, v54
    v_cvt_pk_bf16_f32 v34, v34, v54
    v_and_b32 v54, 0xffff0000, v34
    v_lshlrev_b32 v34, 16, v34
    v_mov_b32 v35, v34
    v_add_f32 v54, 0x3727c5ac, v54
    v_cvt_pk_bf16_f32 v54, v54, v54
    v_and_b32 v54, 0xffff0000, v54
    v_sqrt_f32 v54, v54
    s_nop 0
    v_cvt_pk_bf16_f32 v54, v54, v54
    v_and_b32 v54, 0xffff0000, v54
    v_rcp_f32 v54, v54
    v_lshrrev_b32 v11, 5, v1
    v_mul_u32_u24 v11, 2304, v11
    v_and_b32 v13, 31, v1
    v_mul_u32_u24 v13, 72, v13
    v_add_u32 v11, v11, v13
    v_mov_b32 v55, v54
    v_pk_add_f32 v[16:17], v[16:17], v[34:35] neg_lo:[0,1] neg_hi:[0,1]
    v_pk_add_f32 v[18:19], v[18:19], v[34:35] neg_lo:[0,1] neg_hi:[0,1]
    v_pk_add_f32 v[20:21], v[20:21], v[34:35] neg_lo:[0,1] neg_hi:[0,1]
    v_pk_add_f32 v[22:23], v[22:23], v[34:35] neg_lo:[0,1] neg_hi:[0,1]
    v_pk_add_f32 v[24:25], v[24:25], v[34:35] neg_lo:[0,1] neg_hi:[0,1]
    v_pk_add_f32 v[26:27], v[26:27], v[34:35] neg_lo:[0,1] neg_hi:[0,1]
    v_pk_add_f32 v[28:29], v[28:29], v[34:35] neg_lo:[0,1] neg_hi:[0,1]
    v_pk_add_f32 v[30:31], v[30:31], v[34:35] neg_lo:[0,1] neg_hi:[0,1]
    v_pk_add_f32 v[32:33], v[32:33], v[34:35] neg_lo:[0,1] neg_hi:[0,1]
    v_cvt_pk_bf16_f32 v36, v16, v17
    v_cvt_pk_bf16_f32 v37, v18, v19
    v_cvt_pk_bf16_f32 v38, v20, v21
    v_cvt_pk_bf16_f32 v39, v22, v23
    v_cvt_pk_bf16_f32 v40, v24, v25
    v_cvt_pk_bf16_f32 v41, v26, v27
    v_cvt_pk_bf16_f32 v42, v28, v29
    v_cvt_pk_bf16_f32 v43, v30, v31
    v_cvt_pk_bf16_f32 v44, v32, v33
    s_waitcnt lgkmcnt(0)
    s_add_u32 s52, s52, 1
    s_and_b32 s53, s52, 0xff
    v_mov_b32 v8, s53
    v_mov_b32 v13, 5760
    s_mov_b64 exec, 1
    v_mov_b32 v10, s52
    ds_write_b32 v13, v10 offset:60
    ds_write_b32 v13, v8
    s_mov_b64 exec, -1
    s_mov_b32 s49, 4
    v_lshlrev_b32 v16, 16, v36
    v_and_b32 v17, 0xffff0000, v36
    v_pk_mul_f32 v[16:17], v[16:17], v[54:55]
    v_cvt_pk_bf16_f32 v16, v16, v16
    v_cvt_pk_bf16_f32 v17, v17, v17
    ds_write_b64 v11, v[16:17] offset:0
    v_lshlrev_b32 v18, 16, v37
    v_and_b32 v19, 0xffff0000, v37
    v_pk_mul_f32 v[18:19], v[18:19], v[54:55]
    v_cvt_pk_bf16_f32 v18, v18, v18
    v_cvt_pk_bf16_f32 v19, v19, v19
    ds_write_b64 v11, v[18:19] offset:8
    v_lshlrev_b32 v20, 16, v38
    v_and_b32 v21, 0xffff0000, v38
    v_pk_mul_f32 v[20:21], v[20:21], v[54:55]
    v_cvt_pk_bf16_f32 v20, v20, v20
    v_cvt_pk_bf16_f32 v21, v21, v21
    ds_write_b64 v11, v[20:21] offset:16
    v_lshlrev_b32 v22, 16, v39
    v_and_b32 v23, 0xffff0000, v39
    v_pk_mul_f32 v[22:23], v[22:23], v[54:55]
    v_cvt_pk_bf16_f32 v22, v22, v22
    v_cvt_pk_bf16_f32 v23, v23, v23
    ds_write_b64 v11, v[22:23] offset:24
    v_lshlrev_b32 v24, 16, v40
    v_and_b32 v25, 0xffff0000, v40
    v_pk_mul_f32 v[24:25], v[24:25], v[54:55]
    v_cvt_pk_bf16_f32 v24, v24, v24
    v_cvt_pk_bf16_f32 v25, v25, v25
    ds_write_b64 v11, v[24:25] offset:32
    v_lshlrev_b32 v26, 16, v41
    v_and_b32 v27, 0xffff0000, v41
    v_pk_mul_f32 v[26:27], v[26:27], v[54:55]
    v_cvt_pk_bf16_f32 v26, v26, v26
    v_cvt_pk_bf16_f32 v27, v27, v27
    ds_write_b64 v11, v[26:27] offset:40
    v_lshlrev_b32 v28, 16, v42
    v_and_b32 v29, 0xffff0000, v42
    v_pk_mul_f32 v[28:29], v[28:29], v[54:55]
    v_cvt_pk_bf16_f32 v28, v28, v28
    v_cvt_pk_bf16_f32 v29, v29, v29
    ds_write_b64 v11, v[28:29] offset:48
    v_lshlrev_b32 v30, 16, v43
    v_and_b32 v31, 0xffff0000, v43
    v_pk_mul_f32 v[30:31], v[30:31], v[54:55]
    v_cvt_pk_bf16_f32 v30, v30, v30
    v_cvt_pk_bf16_f32 v31, v31, v31
    ds_write_b64 v11, v[30:31] offset:56
    v_lshlrev_b32 v32, 16, v44
    v_and_b32 v33, 0xffff0000, v44
    v_pk_mul_f32 v[32:33], v[32:33], v[54:55]
    v_cvt_pk_bf16_f32 v32, v32, v32
    v_cvt_pk_bf16_f32 v33, v33, v33
    ds_write_b64 v11, v[32:33] offset:64
    v_lshlrev_b32 v14, 4, v1
    v_mov_b32 v15, 5776
    s_and_b32 s44, s6, 12
    s_lshr_b32 s44, 0x1320, s44
    s_and_b32 s44, s44, 3
    s_lshl2_add_u32 s44, s4, s44
    s_and_b32 s41, s6, 3
    s_lshl2_add_u32 s44, s44, s41
    s_lshl_b32 s44, s44, 10
    s_add_u32 s44, s44, 4096
    s_add_u32 s45, s44, 499712
    s_mov_b32 s51, 1000000
L_spin_74:
    ds_read_b32 v10, v15
    ds_read_b128 v[16:19], v14 offset:20480
    ds_read_b128 v[20:23], v14 offset:21504
    ds_read_b128 v[24:27], v14 offset:22528
    ds_read_b128 v[28:31], v14 offset:23552
    ds_read_b128 v[32:35], v14 offset:24576
    ds_read_b128 v[36:39], v14 offset:25600
    ds_read_b128 v[40:43], v14 offset:26624
    ds_read_b128 v[44:47], v14 offset:27648
    ds_read_b128 v[48:51], v14 offset:28672
    s_waitcnt lgkmcnt(0)
    v_cmp_ne_u32 vcc, 7, v10
    s_cbranch_vccz L_spun_75
    s_sub_u32 s51, s51, 1
    s_cbranch_scc1 L_abort
    s_branch L_spin_74
L_spun_75:
    v_pk_add_f32 v[16:17], v[16:17], v[20:21]
    v_pk_add_f32 v[18:19], v[18:19], v[22:23]
    v_pk_add_f32 v[24:25], v[24:25], v[28:29]
    v_pk_add_f32 v[26:27], v[26:27], v[30:31]
    v_pk_add_f32 v[32:33], v[32:33], v[36:37]
    v_pk_add_f32 v[34:35], v[34:35], v[38:39]
    v_pk_add_f32 v[40:41], v[40:41], v[44:45]
    v_pk_add_f32 v[42:43], v[42:43], v[46:47]
    v_pk_add_f32 v[16:17], v[16:17], v[24:25]
    v_pk_add_f32 v[18:19], v[18:19], v[26:27]
    v_pk_add_f32 v[32:33], v[32:33], v[40:41]
    v_pk_add_f32 v[34:35], v[34:35], v[42:43]
    v_pk_add_f32 v[16:17], v[16:17], v[48:49]
    v_pk_add_f32 v[18:19], v[18:19], v[50:51]
    v_pk_add_f32 v[16:17], v[16:17], v[32:33]
    v_pk_add_f32 v[18:19], v[18:19], v[34:35]
    v_and_or_b32 v16, v16, s50, v8
    v_and_or_b32 v17, v17, s50, v8
    v_and_or_b32 v18, v18, s50, v8
    v_and_or_b32 v19, v19, s50, v8
    buffer_store_dwordx4 v[16:19], v14, s[12:15], s45 offen
    s_setprio 0
    v_mov_b32 v9, 5828
    s_mov_b32 s51, 1000000
L_spin_77:
    ds_read_b32 v10, v9
    s_waitcnt lgkmcnt(0)
    v_cmp_eq_u32 vcc, -2, v10
    s_cbranch_vccz L_spun_78
    s_sub_u32 s51, s51, 1
    s_cbranch_scc1 L_abort
    s_sleep 4
    s_branch L_spin_77
L_spun_78:
    buffer_store_dwordx4 v[16:19], v14, s[12:15], s44 offen sc1
L_M_q2:
    s_mul_i32 s41, s6, 9
    s_add_u32 s42, s41, 8
    s_lshr_b32 s41, s41, 4
    s_lshr_b32 s42, s42, 4
    s_sub_u32 s58, s42, s41
    s_sub_u32 s58, s58, 1
    s_setprio 0
    s_mov_b32 s97, s6
    s_lshr_b32 s89, s4, 1
    s_add_u32 s89, s89, 32
    s_and_b32 s41, s4, 1
    s_lshl4_add_u32 s41, s41, s97
    s_cmp_eq_u32 s41, 29
    s_cbranch_scc1 L_R
    s_endpgm
L_MA:
    s_lshr_b32 s46, s7, 3
    s_lshl_b32 s46, s46, 13
    s_bfe_u32 s47, s6, 0x10002
    s_lshl_b32 s47, s47, 9
    s_add_u32 s46, s46, s47
    s_add_u32 s46, s46, 4096
    s_add_u32 s47, s46, 499712
    s_mov_b32 s48, 0
    v_lshrrev_b32 v11, 5, v1
    v_and_b32 v15, 31, v1
    v_lshlrev_b32 v14, 12, v11
    v_lshl_add_u32 v14, v15, 4, v14
    v_lshlrev_b32 v12, 8, v11
    v_lshl_add_u32 v12, v2, 4, v12
    v_and_b32 v9, 1, v3
    v_lshl_add_u32 v12, v9, 3, v12
    s_waitcnt lgkmcnt(0)
    s_add_u32 s52, s52, 1
    s_and_b32 s53, s52, 0xff
    v_mov_b32 v8, s53
    v_mov_b32 v13, 5760
    s_mov_b64 exec, 1
    v_mov_b32 v10, s52
    ds_write_b32 v13, v10 offset:60
    ds_write_b32 v13, v8
    s_mov_b64 exec, -1
    s_mov_b32 s49, 4
    v_mov_b32 v9, 5788
    s_mov_b32 s51, 1000000
L_spin_80:
    ds_read_b32 v10, v9
    s_waitcnt lgkmcnt(0)
    v_cmp_eq_u32 vcc, -2, v10
    s_cbranch_vccz L_spun_81
    s_sub_u32 s51, s51, 1
    s_cbranch_scc1 L_abort
    s_sleep 2
    s_branch L_spin_80
L_spun_81:
    s_mov_b32 s51, 1000000
    s_add_u32 s48, s48, 1
    s_and_b32 s41, s48, 7
    s_cselect_b32 s42, s47, s46
    buffer_load_dwordx4 v[64:67], v14, s[12:15], s42 offen offset:0 sc1
    buffer_load_dwordx4 v[68:71], v14, s[12:15], s42 offen offset:1024 sc1
    buffer_load_dwordx4 v[72:75], v14, s[12:15], s42 offen offset:2048 sc1
    buffer_load_dwordx4 v[76:79], v14, s[12:15], s42 offen offset:3072 sc1
    s_sleep 12
    s_add_u32 s48, s48, 1
    s_and_b32 s41, s48, 7
    s_cselect_b32 s42, s47, s46
    buffer_load_dwordx4 v[80:83], v14, s[12:15], s42 offen offset:0 sc1
    buffer_load_dwordx4 v[84:87], v14, s[12:15], s42 offen offset:1024 sc1
    buffer_load_dwordx4 v[88:91], v14, s[12:15], s42 offen offset:2048 sc1
    buffer_load_dwordx4 v[92:95], v14, s[12:15], s42 offen offset:3072 sc1
L_poll_83:
    s_waitcnt vmcnt(4)
    v_xor_b32 v16, v64, v8
    v_xor_b32 v17, v65, v8
    v_xor_b32 v18, v66, v8
    v_xor_b32 v19, v67, v8
    v_xor_b32 v20, v68, v8
    v_xor_b32 v21, v69, v8
    v_xor_b32 v22, v70, v8
    v_xor_b32 v23, v71, v8
    v_xor_b32 v24, v72, v8
    v_xor_b32 v25, v73, v8
    v_xor_b32 v26, v74, v8
    v_xor_b32 v27, v75, v8
    v_xor_b32 v28, v76, v8
    v_xor_b32 v29, v77, v8
    v_xor_b32 v30, v78, v8
    v_xor_b32 v31, v79, v8
    v_or3_b32 v9, v16, v17, v18
    v_or3_b32 v9, v9, v19, v20
    v_or3_b32 v9, v9, v21, v22
    v_or3_b32 v9, v9, v23, v24
    v_or3_b32 v9, v9, v25, v26
    v_or3_b32 v9, v9, v27, v28
    v_or3_b32 v9, v9, v29, v30
    v_or_b32 v9, v9, v31
    v_and_b32 v9, 0xff, v9
    v_cmp_ne_u32 vcc, 0, v9
    s_cbranch_vccz L_polled_84
    s_add_u32 s48, s48, 1
    s_and_b32 s41, s48, 7
    s_cselect_b32 s42, s47, s46
    buffer_load_dwordx4 v[64:67], v14, s[12:15], s42 offen offset:0 sc1
    buffer_load_dwordx4 v[68:71], v14, s[12:15], s42 offen offset:1024 sc1
    buffer_load_dwordx4 v[72:75], v14, s[12:15], s42 offen offset:2048 sc1
    buffer_load_dwordx4 v[76:79], v14, s[12:15], s42 offen offset:3072 sc1
    s_waitcnt vmcnt(4)
    v_xor_b32 v16, v80, v8
    v_xor_b32 v17, v81, v8
    v_xor_b32 v18, v82, v8
    v_xor_b32 v19, v83, v8
    v_xor_b32 v20, v84, v8
    v_xor_b32 v21, v85, v8
    v_xor_b32 v22, v86, v8
    v_xor_b32 v23, v87, v8
    v_xor_b32 v24, v88, v8
    v_xor_b32 v25, v89, v8
    v_xor_b32 v26, v90, v8
    v_xor_b32 v27, v91, v8
    v_xor_b32 v28, v92, v8
    v_xor_b32 v29, v93, v8
    v_xor_b32 v30, v94, v8
    v_xor_b32 v31, v95, v8
    v_or3_b32 v9, v16, v17, v18
    v_or3_b32 v9, v9, v19, v20
    v_or3_b32 v9, v9, v21, v22
    v_or3_b32 v9, v9, v23, v24
    v_or3_b32 v9, v9, v25, v26
    v_or3_b32 v9, v9, v27, v28
    v_or3_b32 v9, v9, v29, v30
    v_or_b32 v9, v9, v31
    v_and_b32 v9, 0xff, v9
    v_cmp_ne_u32 vcc, 0, v9
    s_cbranch_vccz L_polled_84
    s_add_u32 s48, s48, 1
    s_and_b32 s41, s48, 7
    s_cselect_b32 s42, s47, s46
    buffer_load_dwordx4 v[80:83], v14, s[12:15], s42 offen offset:0 sc1
    buffer_load_dwordx4 v[84:87], v14, s[12:15], s42 offen offset:1024 sc1
    buffer_load_dwordx4 v[88:91], v14, s[12:15], s42 offen offset:2048 sc1
    buffer_load_dwordx4 v[92:95], v14, s[12:15], s42 offen offset:3072 sc1
    s_sub_u32 s51, s51, 1
    s_cbranch_scc1 L_abort
    s_branch L_poll_83
L_polled_84:
    v_pk_add_f32 v[16:17], v[16:17], v[20:21]
    v_pk_add_f32 v[18:19], v[18:19], v[22:23]
    v_pk_add_f32 v[24:25], v[24:25], v[28:29]
    v_pk_add_f32 v[26:27], v[26:27], v[30:31]
    v_pk_add_f32 v[16:17], v[16:17], v[24:25]
    v_pk_add_f32 v[18:19], v[18:19], v[26:27]
    v_cvt_pk_bf16_f32 v16, v16, v17
    v_cvt_pk_bf16_f32 v17, v18, v19
    ds_write_b64 v12, v[16:17] offset:7168
    v_mov_b32 v9, 5764
    v_mov_b32 v10, 0
    s_mov_b64 exec, 1
    ds_write_b32 v9, v10
    s_mov_b64 exec, -1
    s_mov_b32 s97, s6
    s_lshl2_add_u32 s89, s4, s97
    s_sub_u32 s89, s89, 12
    s_mov_b32 s58, 0
    s_cmp_lt_u32 s97, 12
    s_cbranch_scc1 L_wave_end
L_R:
    s_mul_i32 s46, s89, 9216
    s_lshl_b32 s41, s49, 11
    s_add_u32 s46, s46, s41
    s_add_u32 s46, s46, 1003520
    v_lshlrev_b32 v14, 4, v1
    v_lshlrev_b32 v19, 2, v1
    s_lshl_b32 s41, s49, 8
    v_add_u32 v15, s41, v19
    s_mul_i32 s41, s89, 43
    s_lshr_b32 s41, s41, 9
    s_mul_i32 s42, s41, 12
    s_sub_u32 s42, s89, s42
    s_mul_i32 s41, s41, 192
    s_cmp_ge_u32 s42, 8
    s_cbranch_scc1 L_R_hi
    s_lshr_b32 s43, s42, 2
    s_and_b32 s48, s42, 3
    s_lshl_b32 s48, s48, 5
    s_branch L_R_col
L_R_hi:
    s_bfe_u32 s43, s42, 0x10001
    s_and_b32 s48, s42, 1
    s_lshl_b32 s48, s48, 5
    s_add_u32 s48, s48, 128
L_R_col:
    s_mul_i32 s43, s43, 576
    s_add_u32 s41, s41, s43
    s_add_u32 s41, s41, s48
    s_lshl_b32 s41, s41, 1
    v_and_b32 v12, 7, v1
    v_lshlrev_b32 v12, 3, v12
    v_lshl_add_u32 v12, v3, 1, v12
    v_add_u32 v12, s41, v12
    v_min_u32 v12, 2302, v12
    global_load_ushort v13, v12, s[16:17]
    v_mov_b32 v48, 0
    v_mov_b32 v49, 0
    v_mov_b32 v50, 0
    v_mov_b32 v51, 0
    s_mov_b32 s43, 3216550459
    v_mov_b32 v9, 5784
    s_mov_b32 s51, 1000000
L_spin_85:
    ds_read_b32 v10, v9
    s_waitcnt lgkmcnt(0)
    v_cmp_ne_u32 vcc, s58, v10
    s_cbranch_vccz L_spun_86
    s_sub_u32 s51, s51, 1
    s_cbranch_scc1 L_abort
    s_sleep 2
    s_branch L_spin_85
L_spun_86:
    s_waitcnt vmcnt(0)
    v_lshlrev_b32 v22, 16, v13
    v_readfirstlane_b32 s90, v8
    s_mul_i32 s41, s89, 5
    s_add_u32 s41, s41, s49
    s_mul_i32 s41, s41, 512
    s_add_u32 s41, s41, 1335296
    s_add_u32 s76, s38, s41
    s_addc_u32 s77, s39, 0
    s_mul_i32 s90, s90, 0x01010101
    s_mov_b32 s91, s90
    s_movk_i32 s53, 200
    s_mov_b32 s51, 1000000
    v_mov_b32 v20, 5780
    v_mov_b32 v21, 1
    s_cmp_eq_u32 s49, 4
    s_cbranch_scc0 L_R_full
    s_mov_b32 exec_hi, 0
    s_branch L_hint_88
L_again_89:
    s_sub_u32 s51, s51, 1
    s_cbranch_scc1 L_abort
    s_branch L_read_90
L_hint_88:
    s_sub_u32 s53, s53, 1
    s_cbranch_scc1 L_read_90
    s_load_dwordx2 s[16:17], s[76:77], 0 glc
    s_waitcnt lgkmcnt(0)
    s_xor_b64 s[16:17], s[16:17], s[90:91]
    s_cbranch_scc1 L_hint_88
L_read_90:
    buffer_load_dwordx4 v[48:51], v14, s[12:15], s46 offen sc1
    s_waitcnt vmcnt(0)
    v_xor_b32 v48, v48, v8
    v_xor_b32 v49, v49, v8
    v_xor_b32 v50, v50, v8
    v_xor_b32 v51, v51, v8
    v_or3_b32 v9, v48, v49, v50
    v_or_b32 v9, v9, v51
    v_and_b32 v9, 0xff, v9
    v_cmp_ne_u32 vcc, 0, v9
    s_cbranch_vccnz L_again_89
    s_mov_b32 exec_hi, -1
    s_branch L_R_put
L_R_full:
    s_branch L_hint_91
L_again_92:
    s_sub_u32 s51, s51, 1
    s_cbranch_scc1 L_abort
    s_branch L_read_93
L_hint_91:
    s_sub_u32 s53, s53, 1
    s_cbranch_scc1 L_read_93
    s_load_dwordx2 s[16:17], s[76:77], 0 glc
    s_load_dwordx2 s[18:19], s[76:77], 128 glc
    s_load_dwordx2 s[20:21], s[76:77], 256 glc
    s_load_dwordx2 s[22:23], s[76:77], 384 glc
    s_waitcnt lgkmcnt(0)
    s_xor_b64 s[16:17], s[16:17], s[90:91]
    s_xor_b64 s[18:19], s[18:19], s[90:91]
    s_xor_b64 s[20:21], s[20:21], s[90:91]
    s_xor_b64 s[22:23], s[22:23], s[90:91]
    s_or_b64 s[16:17], s[16:17], s[18:19]
    s_or_b64 s[16:17], s[16:17], s[20:21]
    s_or_b64 s[16:17], s[16:17], s[22:23]
    s_cbranch_scc1 L_hint_91
L_read_93:
    buffer_load_dwordx4 v[48:51], v14, s[12:15], s46 offen sc1
    buffer_load_dwordx4 v[52:55], v14, s[12:15], s46 offen offset:1024 sc1
    s_waitcnt vmcnt(0)
    v_xor_b32 v48, v48, v8
    v_xor_b32 v49, v49, v8
    v_xor_b32 v50, v50, v8
    v_xor_b32 v51, v51, v8
    v_xor_b32 v52, v52, v8
    v_xor_b32 v53, v53, v8
    v_xor_b32 v54, v54, v8
    v_xor_b32 v55, v55, v8
    v_or3_b32 v9, v48, v49, v50
    v_or3_b32 v9, v9, v51, v52
    v_or3_b32 v9, v9, v53, v54
    v_or_b32 v9, v9, v55
    v_and_b32 v9, 0xff, v9
    v_cmp_ne_u32 vcc, 0, v9
    s_cbranch_vccnz L_again_92
    v_pk_add_f32 v[48:49], v[48:49], v[52:53]
    v_pk_add_f32 v[50:51], v[50:51], v[54:55]
L_R_put:
    s_nop 1
    v_permlane32_swap_b32 v48, v50
    v_permlane32_swap_b32 v49, v51
    v_pk_add_f32 v[48:49], v[48:49], v[50:51]
    s_nop 1
    v_permlane16_swap_b32 v48, v49
    v_add_f32 v48, v48, v49
    s_nop 1
    v_add_f32_dpp v48, v48, v48 row_ror:8 row_mask:0xf bank_mask:0xf
    ds_write_b32 v15, v48 offset:12288
    s_mov_b64 exec, 1
    ds_add_rtn_u32 v11, v20, v21
    s_mov_b64 exec, -1
    ds_read2st64_b32 v[26:27], v19 offset0:50 offset1:51
    ds_read_b32 v28, v19 offset:13312
    ds_read2st64_b32 v[24:25], v19 offset0:48 offset1:49
    s_waitcnt lgkmcnt(3)
    v_readfirstlane_b32 s84, v11
    s_nop 0
    s_cmp_eq_u32 s84, 2
    s_cbranch_scc0 L_wave_end
    s_mov_b32 exec_lo, 0x00ff00ff
    s_mov_b32 exec_hi, 0x00ff00ff
    s_waitcnt lgkmcnt(1)
    v_add_f32 v26, v26, v27
    v_add_f32 v26, v26, v28
    s_waitcnt lgkmcnt(0)
    v_add_f32 v24, v24, v25
    v_cvt_pk_bf16_f32 v24, v24, v26
    v_and_b32 v26, 0xffff0000, v24
    v_mul_f32 v27, s43, v26
    v_exp_f32 v27, v27
    v_lshlrev_b32 v24, 16, v24
    v_add_f32 v27, 1.0, v27
    v_rcp_f32 v27, v27
    s_nop 0
    v_mul_f32 v26, v26, v27
    v_cvt_pk_bf16_f32 v26, v26, v26
    v_and_b32 v26, 0xffff0000, v26
    v_mul_f32 v26, v26, v24
    v_cvt_pk_bf16_f32 v26, v26, v26
    v_and_b32 v26, 0xffff0000, v26
    v_add_f32 v26, v26, v22
    v_cvt_pk_bf16_f32 v26, v26, v26
    global_store_short v12, v26, s[34:35]
    s_cmp_lg_u32 s89, 0
    s_cbranch_scc1 L_R_done
    s_mov_b64 exec, 1
    v_mov_b32 v18, 5820
    ds_read_b32 v19, v18
    v_mov_b32 v18, 0
    s_waitcnt lgkmcnt(0)
    buffer_store_dword v19, v18, s[12:15], 0 offen
L_R_done:
    s_endpgm
L_abort:
    s_endpgm
KERNEL_END:
.section .rodata,"a"
.p2align 6
.amdhsa_kernel recurrent_scan__sliding_block_cached__geglu_ffn__decode_kernel
  .amdhsa_next_free_vgpr 128
  .amdhsa_next_free_sgpr 100
  .amdhsa_accum_offset 128
  .amdhsa_group_segment_fixed_size 0
  .amdhsa_kernarg_size 96
  .amdhsa_user_sgpr_count 2
  .amdhsa_user_sgpr_kernarg_segment_ptr 1
  .amdhsa_system_sgpr_workgroup_id_x 1
.end_amdhsa_kernel
```
